```python
import torch

def _softmax(x, axis=-1):
    return torch.softmax(x, dim=axis)
def _gelu(x):
    return torch.nn.functional.gelu(x, approximate="tanh")
def _silu(x):
    return torch.nn.functional.silu(x)
def _sigmoid(x):
    return torch.sigmoid(x)
def _layernorm(x, axis=-1, eps=1e-5):
    m = x.mean(dim=axis, keepdim=True)
    v = x.var(dim=axis, keepdim=True, unbiased=False)
    return (x - m) / torch.sqrt(v + eps)
def _scatter_add(tgt, idx, src, axis=0):
    return tgt.clone().index_add_(axis, idx, src)
def _segment_sum(src, seg, n):
    out = torch.zeros((n,) + src.shape[1:], dtype=src.dtype)
    return out.index_add_(0, seg, src)
def _pad(x, pw):
    flat = tuple(v for pair in reversed(pw) for v in pair)
    return torch.nn.functional.pad(x, flat)

kernel_name = 'parallel_sum__ssm_conv_h3__dense_activation_silu__prompt'

def setup_inputs():

    _w = (lambda a: (lambda t: t.to(torch.bfloat16) if t.is_floating_point() else t)(torch.as_tensor(a)))
    def _A_setup():
        B, S, D = 1, 2048, 512
        ks = 4
        return {
            "q": _w((lambda *s: torch.randn(*s, dtype=torch.bfloat16) * 0.05)(B, S, D)),
            "k": _w((lambda *s: torch.randn(*s, dtype=torch.bfloat16) * 0.2)(B, S, D)),
            "v": _w((lambda *s: torch.randn(*s, dtype=torch.bfloat16) * 0.2)(B, S, D)),
            "shift_k": _w((lambda *s: torch.randn(*s, dtype=torch.bfloat16) * 0.2)(D, ks) * 0.5),
            "ssm_k": _w((lambda *s: torch.randn(*s, dtype=torch.bfloat16) * 0.8)(D, S) * (1.0 / S ** 0.5)),
            "ssm_D": _w((lambda *s: torch.randn(*s, dtype=torch.bfloat16) * 0.2)(D)),
        }
    _A_in = _A_setup()

    def _B_setup():
        B, S, D, F = 1, 2048, 512, 1376
        return {
            "x": _w((lambda *s: torch.randn(*s, dtype=torch.bfloat16) * 0.05)(B, S, D)),
            "w1": _w((lambda *s: torch.randn(*s, dtype=torch.bfloat16) * 0.8)(D, F) * (D ** -0.5)),
            "w2": _w((lambda *s: torch.randn(*s, dtype=torch.bfloat16) * 0.1)(F, D) * (F ** -0.5)),
        }
    _B_in = _B_setup()

    return {
        "A_q": _A_in["q"],
        "A_k": _A_in["k"],
        "A_v": _A_in["v"],
        "A_shift_k": _A_in["shift_k"],
        "A_ssm_k": _A_in["ssm_k"],
        "A_ssm_D": _A_in["ssm_D"],
        "B_x": _B_in["x"],
        "B_w1": _B_in["w1"],
        "B_w2": _B_in["w2"],
    }

def reference(A_q, A_k, A_v, A_shift_k, A_ssm_k, A_ssm_D, B_x, B_w1, B_w2):
    def _A_ref(q, k, v, shift_k, ssm_k, ssm_D):
        B, S, D = q.shape
        ks = shift_k.shape[-1]
        k_pad = _pad(k, ((0, 0), (ks - 1, 0), (0, 0)))
        k_shift = torch.zeros_like(k)
        for t in range(ks):
            k_shift = k_shift + k_pad[:, t:t + S, :] * shift_k[:, ks - 1 - t][None, None, :]
        kv = k_shift * v
        L = 2 * S
        kv_pad = _pad(kv, ((0, 0), (0, S), (0, 0)))
        kf_pad = _pad(ssm_k, ((0, 0), (0, S)))
        kv_f = (lambda x, axes=(-2,-1): torch.fft.rfft2(x.float(), dim=axes))(kv_pad[:, None, :, :], axes=(1, 2))
        kf_f = (lambda x, axes=(-2,-1): torch.fft.rfft2(x.float(), dim=axes))(kf_pad[:, None, :], axes=(1, 2))
        kf_f = (lambda x, *d: x.permute(*d))(kf_f, 1, 2, 0)
        y_f = kv_f * kf_f[None, :, :, :]
        y = (lambda x, s, axes=(-2,-1): torch.fft.irfft2(x, s=s, dim=axes).to(torch.bfloat16))(y_f, (1, L), axes=(1, 2))[:, 0, :S, :]
        y = y + kv * ssm_D[None, None, :]
        return q * y

    def _B_ref(x, w1, w2):
        h = torch.einsum("bsd,df->bsf", x, w1)
        h = _silu(h)
        out = torch.einsum("bsf,fd->bsd", h, w2)
        return out

    x = A_q
    xn = _layernorm(x, axis=-1)
    return x + _A_ref(xn, A_k, A_v, A_shift_k, A_ssm_k, A_ssm_D) + _B_ref(xn, B_w1, B_w2)
```

```asm
; @launch grid=(256,1,1) block=(512,1,1) lds=163840
.amdgcn_target "amdgcn-amd-amdhsa--gfx950"
.text
.globl parallel_sum__ssm_conv_h3__dense_activation_silu__prompt_kernel
.p2align 8
.type parallel_sum__ssm_conv_h3__dense_activation_silu__prompt_kernel,@function
parallel_sum__ssm_conv_h3__dense_activation_silu__prompt_kernel:
    s_lshr_b32 s3, s2, 8
    s_cbranch_scc1 LEND
    s_getpc_b64 s[4:5]
LPC:
    s_lshr_b32 s69, s2, 3
    s_lshl_b32 s80, s69, 10
    v_lshl_add_u32 v9, v0, 1, s80
    v_min_u32 v9, LLAST-LPC, v9
    global_load_ushort v4, v9, s[4:5]
    s_load_dwordx2 s[32:33], s[0:1], 8
    s_load_dwordx2 s[36:37], s[0:1], 16
    s_load_dwordx2 s[40:41], s[0:1], 56
    s_load_dwordx2 s[44:45], s[0:1], 56
    s_load_dwordx2 s[28:29], s[0:1], 0
    s_load_dwordx2 s[10:11], s[0:1], 24
    s_load_dwordx2 s[56:57], s[0:1], 88
    v_lshrrev_b32 v9, 6, v0
    v_and_b32 v1, 63, v0
    v_readfirstlane_b32 s100, v9
    s_and_b32 s68, s2, 7
    s_lshr_b32 s69, s2, 3
    s_mov_b32 s35, 0x20000
    s_and_b32 s70, s100, 3
    s_mul_i32 s91, s70, 7168
    s_cmp_ge_u32 s100, 4
    s_cbranch_scc1 LC
    s_mov_b32 s34, 0x200000
    s_mov_b32 s39, s35
    s_mov_b32 s38, s34
    v_lshrrev_b32 v47, 3, v1
    v_lshlrev_b32 v47, 10, v47
    v_and_b32 v48, 7, v1
    v_lshl_add_u32 v35, v48, 4, v47
    s_lshl_b32 s80, s69, 16
    s_lshl_b32 s81, s70, 14
    s_add_u32 s80, s80, s81
    s_lshl_b32 s81, s68, 7
    s_add_u32 s80, s80, s81
    v_add_u32 v97, s80, v35
    v_add_u32 v96, 0xffffe000, v97
    v_add_u32 v98, 0x2000, v97
    s_add_u32 m0, s91, 86016
    s_waitcnt lgkmcnt(0)
    buffer_load_dwordx4 v96, s[32:35], 0 offen lds
    s_addk_i32 m0, 1024
    s_and_b32 s73, s68, 1
    buffer_load_dwordx4 v97, s[32:35], 0 offen lds
    s_addk_i32 m0, 1024
    s_and_b32 s72, s69, 7
    buffer_load_dwordx4 v98, s[32:35], 0 offen lds
    s_addk_i32 m0, 1024
    s_lshr_b32 s80, s69, 3
    buffer_load_dwordx4 v97, s[36:39], 0 offen lds
    s_addk_i32 m0, 1024
    s_lshr_b32 s71, s68, 1
    buffer_load_dwordx4 v98, s[36:39], 0 offen lds
    s_lshl_b32 s71, s71, 2
    s_add_u32 s71, s71, s80
    s_add_u32 s76, s80, s72
    s_and_b32 s76, s76, 3
    s_mul_i32 s75, s73, 22
    s_mul_i32 s81, s72, 3
    s_add_u32 s75, s75, s81
    s_add_u32 s81, s72, s73
    s_max_u32 s82, s81, 6
    s_sub_u32 s82, s82, 6
    s_sub_u32 s75, s75, s82
    s_cmp_lt_u32 s81, 6
    s_cselect_b32 s46, 1409024, 0
    s_cselect_b32 s62, 16777216, 0
    s_and_b32 s3, s70, 1
    s_lshr_b32 s27, s70, 1
    s_mov_b32 s59, s35
    s_mov_b32 s58, 16777216
    s_mov_b32 s31, s35
    s_mov_b32 s30, s34
    s_mov_b32 s43, s35
    s_mov_b32 s42, 1409024
    s_mov_b32 s47, s35
    s_lshl_b32 s80, s70, 4
    v_lshrrev_b32 v51, 2, v1
    v_add_u32 v51, s80, v51
    v_mul_u32_u24 v51, 2752, v51
    v_and_b32 v46, 3, v1
    v_lshl_add_u32 v51, v46, 4, v51
    s_lshl_b32 s80, s75, 6
    v_add_u32 v14, s80, v51
    s_lshl_b32 s81, s68, 9
    v_lshl_add_u32 v99, v1, 3, s81
    v_lshrrev_b32 v50, 4, v1
    v_xor_b32 v50, v48, v50
    v_lshl_add_u32 v50, v50, 4, v47
    s_lshl_b32 s80, s71, 17
    s_lshl_b32 s81, s70, 15
    s_add_u32 s80, s80, s81
    v_add_u32 v10, s80, v50
    v_xor_b32 v11, 64, v10
    v_add_u32 v11, 0x2000, v11
    v_add_u32 v12, 0x4000, v10
    v_add_u32 v13, 0x4000, v11
    global_load_dwordx2 v[52:53], v99, s[10:11]
    s_lshl_b32 s77, s76, 7
    s_mul_i32 s78, s76, 176128
    s_add_u32 m0, s91, 0
    s_add_u32 s76, s76, 1
    buffer_load_dwordx4 v14, s[40:43], s78 offen offset:0 lds
    s_add_u32 m0, s91, 960
    s_and_b32 s76, s76, 3
    buffer_load_dwordx4 v14, s[40:43], s78 offen offset:64 lds
    s_add_u32 m0, s91, 1920
    s_nop 0
    buffer_load_dwordx4 v14, s[44:47], s78 offen offset:128 lds
    s_add_u32 m0, s91, 3072
    s_nop 0
    buffer_load_dwordx4 v10, s[28:31], s77 offen lds
    s_add_u32 s6, s56, 6160384
    s_addc_u32 s7, s57, 0
    s_load_dword s74, s[6:7], 0
    s_load_dwordx2 s[60:61], s[0:1], 88
    s_load_dwordx2 s[52:53], s[0:1], 32
    s_load_dwordx2 s[14:15], s[0:1], 40
    s_load_dwordx2 s[48:49], s[0:1], 64
    s_load_dwordx2 s[64:65], s[0:1], 72
    v_lshlrev_b32 v0, 2, v1
    v_lshlrev_b32 v2, 4, v1
    v_lshrrev_b32 v5, 2, v1
    v_lshlrev_b32 v5, 7, v5
    v_mov_b32 v8, 1
    s_lshl_b32 s80, s70, 2
    s_add_u32 s80, s80, 122880
    v_mov_b32 v6, s80
    v_and_b32 v7, 3, v1
    v_lshlrev_b32 v7, 2, v7
    v_add_u32 v7, 122880, v7
    v_bfe_u32 v47, v1, 2, 2
    v_lshrrev_b32 v48, 4, v1
    v_lshlrev_b32 v48, 5, v48
    v_lshl_add_u32 v48, v47, 7, v48
    v_lshl_add_u32 v48, v46, 3, v48
    s_add_u32 s80, s91, 86016
    v_add_u32 v20, s80, v48
    s_lshl_b32 s80, s70, 5
    s_sub_u32 s80, 142688, s80
    v_mul_u32_u24 v48, 144, v1
    v_add_u32 v21, s80, v48
    s_lshl_b32 s80, s70, 4
    v_lshrrev_b32 v48, 3, v1
    v_add_u32 v49, s80, v48
    v_and_b32 v50, 7, v1
    v_lshlrev_b32 v50, 4, v50
    v_mul_u32_u24 v22, 144, v49
    v_add_u32 v22, v22, v50
    v_add_u32 v22, 142592, v22
    v_lshl_add_u32 v23, v49, 12, v50
    v_add_u32 v24, 0x8000, v23
    s_lshl_b32 s80, s68, 18
    s_lshl_b32 s81, s69, 7
    s_sub_u32 s80, s80, s81
    s_add_u32 s12, s80, 6508416
    v_lshlrev_b32 v51, 2, v1
    v_add_u32 v51, 122880, v51
    v_mov_b32 v48, 0
    ds_write_b32 v51, v48
    s_lshl_b32 s81, s69, 1
    s_add_u32 s81, s81, s27
    s_lshl_b32 s82, s68, 1
    s_add_u32 s82, s82, s3
    s_lshl_b32 s82, s82, 6
    s_add_u32 s82, s82, s81
    s_lshl_b32 s82, s82, 7
    s_add_u32 s20, s82, 6029312
    s_waitcnt lgkmcnt(0)
    s_mul_i32 s74, s74, 1664525
    s_add_u32 s74, s74, 1013904223
    v_mov_b32 v3, s74
    s_add_u32 m0, s91, 4096
    s_nop 0
    buffer_load_dwordx4 v11, s[28:31], s77 offen lds
    s_add_u32 m0, s91, 5120
    s_nop 0
    buffer_load_dwordx4 v12, s[28:31], s77 offen lds
    s_add_u32 m0, s91, 6144
    s_nop 0
    buffer_load_dwordx4 v13, s[28:31], s77 offen lds
    s_waitcnt vmcnt(7)
    ds_read_b64_tr_b16 v[96:97], v20 offset:512
    ds_read_b64_tr_b16 v[98:99], v20 offset:1024
    ds_read_b64_tr_b16 v[100:101], v20 offset:1536
    ds_read_b64_tr_b16 v[102:103], v20 offset:2048
    ds_read_b64_tr_b16 v[104:105], v20 offset:2560
    ds_read_b64_tr_b16 v[106:107], v20 offset:3072
    ds_read_b64_tr_b16 v[108:109], v20 offset:3584
    ds_read_b64_tr_b16 v[110:111], v20 offset:4096
    ds_read_b64_tr_b16 v[112:113], v20 offset:4608
    s_lshl_b32 s77, s76, 7
    s_mul_i32 s78, s76, 176128
    s_add_u32 m0, s91, 28672
    s_add_u32 s76, s76, 1
    buffer_load_dwordx4 v14, s[40:43], s78 offen offset:0 lds
    s_add_u32 m0, s91, 29632
    s_and_b32 s76, s76, 3
    buffer_load_dwordx4 v14, s[40:43], s78 offen offset:64 lds
    s_add_u32 m0, s91, 30592
    s_nop 0
    buffer_load_dwordx4 v14, s[44:47], s78 offen offset:128 lds
    v_alignbit_b32 v54, v52, v52, 16
    v_alignbit_b32 v55, v53, v53, 16
    s_waitcnt lgkmcnt(4)
    v_alignbit_b32 v114, v97, v96, 16
    v_alignbit_b32 v115, v98, v97, 16
    v_alignbit_b32 v116, v99, v98, 16
    v_alignbit_b32 v117, v100, v99, 16
    v_alignbit_b32 v118, v101, v100, 16
    v_alignbit_b32 v119, v102, v101, 16
    v_alignbit_b32 v120, v103, v102, 16
    v_alignbit_b32 v121, v104, v103, 16
    v_alignbit_b32 v122, v105, v104, 16
    v_dot2_f32_bf16 v124, v114, v55, 0
    v_dot2_f32_bf16 v125, v97, v55, 0
    v_dot2_f32_bf16 v126, v115, v55, 0
    v_dot2_f32_bf16 v127, v98, v55, 0
    v_dot2_f32_bf16 v128, v116, v55, 0
    v_dot2_f32_bf16 v129, v99, v55, 0
    v_dot2_f32_bf16 v130, v117, v55, 0
    v_dot2_f32_bf16 v131, v100, v55, 0
    v_dot2_f32_bf16 v132, v118, v55, 0
    v_dot2_f32_bf16 v133, v101, v55, 0
    v_dot2_f32_bf16 v134, v119, v55, 0
    v_dot2_f32_bf16 v135, v102, v55, 0
    v_dot2_f32_bf16 v136, v120, v55, 0
    v_dot2_f32_bf16 v137, v103, v55, 0
    v_dot2_f32_bf16 v138, v121, v55, 0
    v_dot2_f32_bf16 v139, v104, v55, 0
    v_dot2_f32_bf16 v124, v115, v54, v124
    v_dot2_f32_bf16 v125, v98, v54, v125
    v_dot2_f32_bf16 v126, v116, v54, v126
    v_dot2_f32_bf16 v127, v99, v54, v127
    v_dot2_f32_bf16 v128, v117, v54, v128
    v_dot2_f32_bf16 v129, v100, v54, v129
    v_dot2_f32_bf16 v130, v118, v54, v130
    v_dot2_f32_bf16 v131, v101, v54, v131
    v_dot2_f32_bf16 v132, v119, v54, v132
    v_dot2_f32_bf16 v133, v102, v54, v133
    v_dot2_f32_bf16 v134, v120, v54, v134
    v_dot2_f32_bf16 v135, v103, v54, v135
    v_dot2_f32_bf16 v136, v121, v54, v136
    v_dot2_f32_bf16 v137, v104, v54, v137
    v_dot2_f32_bf16 v138, v122, v54, v138
    v_dot2_f32_bf16 v139, v105, v54, v139
    s_add_u32 m0, s91, 31744
    s_nop 0
    buffer_load_dwordx4 v10, s[28:31], s77 offen lds
    s_add_u32 m0, s91, 32768
    s_nop 0
    buffer_load_dwordx4 v11, s[28:31], s77 offen lds
    s_waitcnt lgkmcnt(0)
    v_lshlrev_b32 v96, 16, v106
    v_and_b32 v97, 0xffff0000, v106
    v_lshlrev_b32 v98, 16, v107
    v_and_b32 v99, 0xffff0000, v107
    v_lshlrev_b32 v100, 16, v108
    v_and_b32 v101, 0xffff0000, v108
    v_lshlrev_b32 v102, 16, v109
    v_and_b32 v103, 0xffff0000, v109
    v_lshlrev_b32 v114, 16, v110
    v_and_b32 v115, 0xffff0000, v110
    v_lshlrev_b32 v116, 16, v111
    v_and_b32 v117, 0xffff0000, v111
    v_lshlrev_b32 v118, 16, v112
    v_and_b32 v119, 0xffff0000, v112
    v_lshlrev_b32 v120, 16, v113
    v_and_b32 v121, 0xffff0000, v113
    v_pk_mul_f32 v[124:125], v[124:125], v[96:97]
    v_pk_mul_f32 v[126:127], v[126:127], v[98:99]
    v_pk_mul_f32 v[128:129], v[128:129], v[100:101]
    v_pk_mul_f32 v[130:131], v[130:131], v[102:103]
    v_pk_mul_f32 v[132:133], v[132:133], v[114:115]
    v_pk_mul_f32 v[134:135], v[134:135], v[116:117]
    v_pk_mul_f32 v[136:137], v[136:137], v[118:119]
    v_pk_mul_f32 v[138:139], v[138:139], v[120:121]
    v_cvt_pk_bf16_f32 v106, v139, v138
    v_cvt_pk_bf16_f32 v107, v137, v136
    v_cvt_pk_bf16_f32 v108, v135, v134
    v_cvt_pk_bf16_f32 v109, v133, v132
    v_cvt_pk_bf16_f32 v110, v131, v130
    v_cvt_pk_bf16_f32 v111, v129, v128
    v_cvt_pk_bf16_f32 v112, v127, v126
    v_cvt_pk_bf16_f32 v113, v125, v124
    ds_write_b128 v21, v[106:109]
    ds_write_b128 v21, v[110:113] offset:16
    s_add_u32 m0, s91, 33792
    s_nop 0
    buffer_load_dwordx4 v12, s[28:31], s77 offen lds
    s_add_u32 m0, s91, 34816
    s_nop 0
    buffer_load_dwordx4 v13, s[28:31], s77 offen lds
    s_waitcnt lgkmcnt(0)
    s_barrier
    ds_read_b128 v[106:109], v22
    ds_read_b128 v[110:113], v22 offset:1152
    s_waitcnt lgkmcnt(0)
    v_not_b32 v140, v3
    s_mov_b32 exec_hi, 0
    buffer_store_dword v140, v0, s[56:59], s20 offen sc1
    s_mov_b32 exec_hi, -1
    buffer_store_dwordx4 v[106:109], v23, s[56:59], s12 offen sc1
    buffer_store_dwordx4 v[110:113], v24, s[56:59], s12 offen sc1
    s_waitcnt vmcnt(10)
    s_barrier
    s_lshl_b32 s77, s76, 7
    s_mul_i32 s78, s76, 176128
    s_add_u32 m0, s91, 57344
    s_add_u32 s76, s76, 1
    buffer_load_dwordx4 v14, s[40:43], s78 offen offset:0 lds
    s_add_u32 m0, s91, 58304
    s_and_b32 s76, s76, 3
    buffer_load_dwordx4 v14, s[40:43], s78 offen offset:64 lds
    s_add_u32 m0, s91, 59264
    s_nop 0
    buffer_load_dwordx4 v14, s[44:47], s78 offen offset:128 lds
    s_add_u32 m0, s91, 60416
    s_nop 0
    buffer_load_dwordx4 v10, s[28:31], s77 offen lds
    s_add_u32 m0, s91, 61440
    s_nop 0
    buffer_load_dwordx4 v11, s[28:31], s77 offen lds
    s_add_u32 m0, s91, 62464
    s_nop 0
    buffer_load_dwordx4 v12, s[28:31], s77 offen lds
    s_add_u32 m0, s91, 63488
    s_nop 0
    buffer_load_dwordx4 v13, s[28:31], s77 offen lds
    s_lshl_b32 s77, s76, 7
    s_mul_i32 s78, s76, 176128
    s_add_u32 m0, s91, 86016
    s_add_u32 s76, s76, 1
    buffer_load_dwordx4 v14, s[40:43], s78 offen offset:0 lds
    s_add_u32 m0, s91, 86976
    s_and_b32 s76, s76, 3
    buffer_load_dwordx4 v14, s[40:43], s78 offen offset:64 lds
    s_lshl_b32 s80, s68, 2
    s_add_u32 s81, s80, s70
    s_lshl_b32 s81, s81, 5
    s_add_u32 s81, s81, s69
    s_lshl_b32 s81, s81, 7
    s_add_u32 s13, s81, 5767168
    s_lshr_b32 s81, s69, 3
    s_add_u32 s80, s80, s81
    s_lshl_b32 s80, s80, 12
    s_add_u32 s16, s80, 5767168
    s_mov_b32 s51, s35
    s_mov_b32 s50, s42
    s_mov_b32 s67, s35
    s_mov_b32 s66, s34
    s_mov_b32 s55, s35
    s_mov_b32 s54, 4096
    s_lshl_b32 s79, s70, 10
    v_xor_b32 v9, 4, v6
    s_lshl_b32 s80, s3, 13
    s_lshl_b32 s81, s72, 7
    s_add_u32 s80, s80, s81
    v_and_b32 v49, 16, v1
    v_lshlrev_b32 v49, 2, v49
    v_xor_b32 v48, v35, v49
    v_add_u32 v16, s80, v48
    v_add_u32 v17, 16384, v16
    v_add_u32 v18, 32768, v16
    v_add_u32 v19, 49152, v16
    s_and_b32 s81, s71, 3
    s_mul_i32 s81, s81, 5
    s_add_u32 s81, s81, 1
    s_lshr_b32 s81, s81, 1
    s_add_u32 s80, s72, s81
    s_sub_u32 s81, s80, 10
    s_min_u32 s80, s80, s81
    s_mul_i32 s81, s27, 43
    s_lshl_b32 s85, s81, 14
    s_add_u32 s86, s85, 655360
    s_lshl_b32 s82, s80, 16
    s_add_u32 s84, s85, s82
    v_lshrrev_b32 v46, 5, v1
    s_lshl_b32 s80, s68, 6
    s_lshl_b32 s81, s69, 1
    s_add_u32 s81, s81, s27
    s_add_u32 s8, s80, s81
    s_waitcnt vmcnt(12)
    s_barrier
    s_add_u32 m0, s91, 87936
    s_or_b32 s76, s76, 4
    buffer_load_dwordx4 v14, s[44:47], s78 offen offset:128 lds
    s_add_u32 m0, s91, 89088
    s_nop 0
    buffer_load_dwordx4 v10, s[28:31], s77 offen lds
    s_add_u32 m0, s91, 90112
    s_nop 0
    buffer_load_dwordx4 v11, s[28:31], s77 offen lds
    s_add_u32 m0, s91, 91136
    s_nop 0
    buffer_load_dwordx4 v12, s[28:31], s77 offen lds
    s_add_u32 m0, s91, 92160
    s_nop 0
    buffer_load_dwordx4 v13, s[28:31], s77 offen lds
    s_lshl_b32 s77, s76, 7
    s_mul_i32 s78, s76, 176128
    s_add_u32 m0, s91, 0
    s_add_u32 s76, s76, 1
    buffer_load_dwordx4 v14, s[40:43], s78 offen offset:0 lds
    s_add_u32 m0, s91, 960
    s_and_b32 s76, s76, 3
    buffer_load_dwordx4 v14, s[40:43], s78 offen offset:64 lds
    s_add_u32 m0, s91, 1920
    s_or_b32 s76, s76, 4
    buffer_load_dwordx4 v14, s[44:47], s78 offen offset:128 lds
    s_add_u32 m0, s91, 3072
    s_nop 0
    buffer_load_dwordx4 v10, s[28:31], s77 offen lds
    s_add_u32 m0, s91, 4096
    s_nop 0
    buffer_load_dwordx4 v11, s[28:31], s77 offen lds
    s_add_u32 m0, s91, 5120
    s_nop 0
    buffer_load_dwordx4 v12, s[28:31], s77 offen lds
    s_add_u32 m0, s91, 6144
    s_nop 0
    buffer_load_dwordx4 v13, s[28:31], s77 offen lds
    s_lshl_b32 s82, s68, 1
    s_add_u32 s82, s82, s3
    s_lshl_b32 s82, s82, 6
    s_add_u32 s82, s82, s81
    s_lshl_b32 s82, s82, 7
    s_add_u32 s20, s82, 6029312
    s_lshl_b32 s80, s8, 12
    s_add_u32 s52, s52, s80
    s_addc_u32 s53, s53, 0
    s_lshl_b32 s81, s3, 11
    s_add_u32 s80, s80, s81
    s_add_u32 s22, s80, 6504448
    s_add_u32 s21, s80, 8642560
    v_add_u32 v25, s81, v2
    s_mul_i32 s82, s27, 8448
    s_add_u32 s82, s82, 125696
    s_mul_i32 s83, s27, 9152
    s_add_u32 s83, s83, 142592
    s_add_u32 s24, s82, s81
    v_add_u32 v26, s83, v25
    s_lshl_b32 s80, s3, 12
    s_add_u32 s81, s82, s80
    v_add_u32 v30, s81, v2
    s_xor_b32 s80, s80, 4096
    s_add_u32 s81, s82, s80
    v_add_u32 v31, s81, v2
    v_lshrrev_b32 v48, 1, v1
    v_lshlrev_b32 v15, 7, v48
    s_add_u32 s80, s83, 8096
    v_add_u32 v27, s80, v2
    s_add_u32 s80, s83, 3968
    v_add_u32 v48, s80, v2
    v_cmp_gt_u32 vcc, 36, v1
    s_add_u32 s80, s82, 4160
    v_add_u32 v49, s80, v2
    v_cndmask_b32 v27, v27, v48, vcc
    v_cmp_gt_u32 vcc, 8, v1
    v_add_u32 v48, s82, v2
    s_nop 0
    v_cndmask_b32 v27, v27, v49, vcc
    v_cmp_gt_u32 vcc, 4, v1
    s_nop 1
    v_cndmask_b32 v27, v27, v48, vcc
    s_lshl_b32 s80, s3, 8
    v_and_b32 v48, 15, v1
    s_waitcnt vmcnt(14)
    s_barrier
    s_mov_b32 exec_hi, 0
    buffer_store_dword v3, v0, s[56:59], s13 offen sc1
    s_mov_b32 exec_hi, -1
    s_lshl_b32 s77, s76, 7
    s_mul_i32 s78, s76, 176128
    s_add_u32 m0, s91, 28672
    s_add_u32 s76, s76, 1
    buffer_load_dwordx4 v14, s[40:43], s78 offen offset:0 lds
    s_add_u32 m0, s91, 29632
    s_and_b32 s76, s76, 3
    buffer_load_dwordx4 v14, s[40:43], s78 offen offset:64 lds
    s_add_u32 m0, s91, 30592
    s_or_b32 s76, s76, 4
    buffer_load_dwordx4 v14, s[44:47], s78 offen offset:128 lds
    s_add_u32 m0, s91, 31744
    s_nop 0
    buffer_load_dwordx4 v10, s[28:31], s77 offen lds
    s_add_u32 m0, s91, 32768
    s_nop 0
    buffer_load_dwordx4 v11, s[28:31], s77 offen lds
    s_add_u32 m0, s91, 33792
    s_nop 0
    buffer_load_dwordx4 v12, s[28:31], s77 offen lds
    v_and_b32 v49, 48, v1
    v_and_b32 v50, 14, v1
    v_lshlrev_b32 v50, 5, v50
    v_and_b32 v47, 1, v1
    v_xor_b32 v51, 1, v47
    v_mul_u32_u24 v28, 4224, v51
    v_mul_u32_u24 v51, 4576, v51
    v_sub_u32 v51, v51, v50
    s_add_u32 s81, s83, s80
    s_add_u32 s81, s81, 448
    v_add3_u32 v29, v51, v49, s81
    v_add_u32 v48, 1, v48
    v_lshrrev_b32 v48, 1, v48
    v_lshl_add_u32 v28, v48, 3, v28
    s_add_u32 s81, s82, s80
    v_add3_u32 v28, v28, v49, s81
    s_lshl_b32 s80, s3, 11
    s_sub_u32 s80, s83, s80
    s_add_u32 s80, s80, 2544
    v_sub_u32 v51, v51, v49
    v_add_u32 v32, s80, v51
    v_and_b32 v49, 16, v1
    v_lshl_add_u32 v33, v49, 5, v50
    v_lshl_add_u32 v33, v46, 5, v33
    v_lshl_add_u32 v33, v47, 4, v33
    s_lshl_b32 s80, s72, 1
    s_lshr_b32 s81, s71, 3
    s_add_u32 s80, s80, s81
    s_lshl_b32 s80, s80, 2
    s_add_u32 s80, s80, s70
    s_lshl_b32 s80, s80, 11
    s_add_u32 s18, s80, 6029312
    s_lshl_b32 s80, s72, 18
    s_lshl_b32 s81, s71, 8
    s_add_u32 s80, s80, s81
    s_lshl_b32 s81, s73, 7
    s_add_u32 s80, s80, s81
    s_add_u32 s23, s80, 8642560
    s_lshl_b32 s80, s71, 17
    s_lshl_b32 s81, s73, 16
    s_add_u32 s80, s80, s81
    s_lshl_b32 s81, s70, 14
    s_add_u32 s80, s80, s81
    s_lshl_b32 s81, s72, 7
    s_add_u32 s25, s80, s81
    s_waitcnt vmcnt(14)
    s_barrier
    s_add_u32 m0, s91, 34816
    s_nop 0
    buffer_load_dwordx4 v13, s[28:31], s77 offen lds
    s_lshl_b32 s77, s76, 7
    s_mul_i32 s78, s76, 176128
    s_add_u32 m0, s91, 57344
    s_add_u32 s76, s76, 1
    buffer_load_dwordx4 v14, s[40:43], s78 offen offset:0 lds
    s_add_u32 m0, s91, 58304
    s_and_b32 s76, s76, 3
    buffer_load_dwordx4 v14, s[40:43], s78 offen offset:64 lds
    s_add_u32 m0, s91, 59264
    s_or_b32 s76, s76, 4
    buffer_load_dwordx4 v14, s[44:47], s78 offen offset:128 lds
    s_add_u32 m0, s91, 60416
    s_nop 0
    buffer_load_dwordx4 v10, s[28:31], s77 offen lds
    s_add_u32 m0, s91, 61440
    s_nop 0
    buffer_load_dwordx4 v11, s[28:31], s77 offen lds
    s_add_u32 m0, s91, 62464
    s_nop 0
    buffer_load_dwordx4 v12, s[28:31], s77 offen lds
    s_lshr_b32 s80, s8, 1
    s_lshl_b32 s80, s80, 2
    v_mov_b32 v34, s80
    s_lshl_b32 s80, s70, 4
    v_lshrrev_b32 v48, 3, v1
    v_add_u32 v49, s80, v48
    v_and_b32 v50, 7, v1
    v_lshlrev_b32 v50, 4, v50
    v_mul_u32_u24 v42, 272, v49
    v_lshl_add_u32 v42, v50, 1, v42
    v_add_u32 v42, 45056, v42
    s_lshl_b32 s80, s73, 9
    s_add_u32 s80, s80, 124672
    v_lshl_add_u32 v41, v49, 3, s80
    s_lshl_b32 s80, s70, 5
    v_xor_b32 v51, s80, v50
    v_lshl_add_u32 v37, v49, 7, v51
    v_add_u32 v37, 81920, v37
    v_xor_b32 v38, 16, v37
    v_lshl_add_u32 v51, v50, 6, v51
    v_and_b32 v49, 1, v48
    v_lshlrev_b32 v49, 4, v49
    v_xor_b32 v51, v51, v49
    v_and_b32 v49, 6, v48
    v_add3_u32 v39, v51, v49, 0
    v_add_u32 v39, 81920, v39
    v_add_u32 v36, 0x2000, v35
    s_waitcnt vmcnt(14)
    s_barrier
    s_add_u32 m0, s91, 63488
    s_nop 0
    buffer_load_dwordx4 v13, s[28:31], s77 offen lds
    s_lshl_b32 s77, s76, 7
    s_mul_i32 s78, s76, 176128
    s_add_u32 m0, s91, 86016
    s_add_u32 s76, s76, 1
    buffer_load_dwordx4 v14, s[40:43], s78 offen offset:0 lds
    s_add_u32 m0, s91, 86976
    s_and_b32 s76, s76, 3
    buffer_load_dwordx4 v14, s[40:43], s78 offen offset:64 lds
    s_add_u32 m0, s91, 87936
    s_or_b32 s76, s76, 8
    buffer_load_dwordx4 v14, s[44:47], s78 offen offset:128 lds
    s_add_u32 m0, s91, 89088
    s_nop 0
    buffer_load_dwordx4 v10, s[28:31], s77 offen lds
    s_add_u32 m0, s91, 90112
    s_nop 0
    buffer_load_dwordx4 v11, s[28:31], s77 offen lds
    s_add_u32 m0, s91, 91136
    s_nop 0
    buffer_load_dwordx4 v12, s[28:31], s77 offen lds
    s_add_u32 m0, s91, 92160
    s_nop 0
    buffer_load_dwordx4 v13, s[28:31], s77 offen lds
    s_waitcnt vmcnt(14)
    s_barrier
    buffer_load_dword v4, v15, s[56:59], s16 offen sc1
    buffer_load_dword v59, off, s[52:55], 0
    global_load_dword v34, v34, s[14:15]
    s_add_u32 m0, s24, 64
    s_nop 0
    buffer_load_dwordx4 v25, s[52:55], 0 offen offset:0 lds
    s_add_u32 m0, s24, 64
    s_nop 0
    buffer_load_dwordx4 v25, s[52:55], 0 offen offset:1024 lds
    s_waitcnt vmcnt(12)
    s_barrier
    s_add_u32 m0, s79, 114688
    s_nop 0
    buffer_load_dwordx4 v16, s[48:51], s86 offen lds
    s_add_u32 m0, s79, 118784
    s_nop 0
    buffer_load_dwordx4 v17, s[48:51], s86 offen lds
    s_add_u32 m0, s79, 0
    s_nop 0
    buffer_load_dwordx4 v18, s[48:51], s86 offen lds
    s_add_u32 m0, s79, 4096
    s_nop 0
    buffer_load_dwordx4 v16, s[48:51], s84 offen lds
    s_waitcnt vmcnt(9)
    s_barrier
    s_waitcnt vmcnt(8)
    v_cmp_ne_u32 vcc, s74, v4
    s_nop 1
    s_cbranch_vccnz LSLOWH3
LOKH1:
    buffer_load_dwordx4 v[224:227], v2, s[56:59], s22 offen sc1
    buffer_load_dwordx4 v[228:231], v2, s[56:59], s22 offen offset:1024 sc1
    buffer_load_dword v233, off, s[56:59], s22 offset:2048 sc1
    s_add_u32 m0, s24, 4288
    s_nop 0
    buffer_load_dwordx4 v25, s[52:55], 4 offen offset:0 lds
    s_add_u32 m0, s24, 4288
    s_nop 0
    buffer_load_dwordx4 v25, s[52:55], 4 offen offset:1024 lds
    s_waitcnt vmcnt(12)
    s_add_u32 m0, s79, 8192
    s_nop 0
    buffer_load_dwordx4 v17, s[48:51], s84 offen lds
    s_waitcnt vmcnt(12)
    s_add_u32 m0, s79, 12288
    s_nop 0
    buffer_load_dwordx4 v18, s[48:51], s84 offen lds
    s_waitcnt vmcnt(12)
    s_add_u32 m0, s79, 16384
    s_nop 0
    buffer_load_dwordx4 v19, s[48:51], s84 offen lds
    s_add_u32 s84, s84, 65536
    s_cmp_ge_u32 s84, s86
    s_cselect_b32 s84, s85, s84
    s_waitcnt vmcnt(12)
    s_add_u32 m0, s79, 20480
    s_nop 0
    buffer_load_dwordx4 v16, s[48:51], s84 offen lds
    s_waitcnt vmcnt(12)
    s_add_u32 m0, s79, 24576
    s_nop 0
    buffer_load_dwordx4 v17, s[48:51], s84 offen lds
    s_waitcnt vmcnt(12)
    s_add_u32 m0, s79, 28672
    s_nop 0
    buffer_load_dwordx4 v18, s[48:51], s84 offen lds
    s_waitcnt vmcnt(12)
    s_waitcnt vmcnt(8)
    ds_write_b128 v26, v[224:227]
    ds_write_b128 v26, v[228:231] offset:1024
    v_readlane_b32 s81, v228, 0
    s_sub_u32 s80, s3, 1
    v_and_b32 v233, s80, v233
    v_cmp_eq_u32 vcc, 7, v1
    v_mov_b32 v232, s81
    v_mov_b32 v56, 0
    v_mov_b32 v57, 0
    v_mov_b32 v58, 0
    v_cndmask_b32 v59, 0, v59, vcc
    v_mov_b32_dpp v232, v224 wave_shl:1 row_mask:0xf bank_mask:0xf
    v_mov_b32_dpp v233, v228 wave_shl:1 row_mask:0xf bank_mask:0xf
    ds_write_b128 v27, v[56:59]
    v_alignbit_b32 v236, v225, v224, 16
    v_alignbit_b32 v237, v226, v225, 16
    v_alignbit_b32 v238, v227, v226, 16
    v_alignbit_b32 v239, v232, v227, 16
    ds_write_b128 v26, v[236:239] offset:4576
    v_alignbit_b32 v240, v229, v228, 16
    v_alignbit_b32 v241, v230, v229, 16
    v_alignbit_b32 v242, v231, v230, 16
    v_alignbit_b32 v243, v233, v231, 16
    ds_write_b128 v26, v[240:243] offset:5600
    s_and_b32 s80, s8, 1
    s_lshl_b32 s80, s80, 4
    v_lshrrev_b32 v34, s80, v34
    v_lshlrev_b32 v34, 16, v34
    s_waitcnt vmcnt(6)
    ds_write_b32 v6, v8 offset:32
    ds_read_b32 v46, v9 offset:32
    s_waitcnt lgkmcnt(0)
    v_cmp_ne_u32 vcc, 1, v46
    s_nop 1
    s_cbranch_vccnz LSLH6
LOKH4:
    ds_read_b64 v[96:97], v28 offset:0
    ds_read_b64 v[98:99], v28 offset:8
    ds_read_b128 v[128:131], v29 offset:3584
    ds_read_b128 v[132:135], v29 offset:3072
    ds_read_b128 v[136:139], v29 offset:2560
    ds_read_b128 v[140:143], v29 offset:2048
    ds_read_b128 v[144:147], v29 offset:1536
    ds_read_b128 v[148:151], v29 offset:1024
    ds_read_b128 v[152:155], v29 offset:512
    ds_read_b128 v[156:159], v29 offset:0
    ds_read_b64 v[100:101], v28 offset:512
    ds_read_b64 v[102:103], v28 offset:520
    ds_read_b64 v[104:105], v28 offset:1024
    ds_read_b64 v[106:107], v28 offset:1032
    ds_read_b64 v[108:109], v28 offset:1536
    ds_read_b64 v[110:111], v28 offset:1544
    ds_read_b64 v[112:113], v28 offset:2048
    ds_read_b64 v[114:115], v28 offset:2056
    ds_read_b64 v[116:117], v28 offset:2560
    ds_read_b64 v[118:119], v28 offset:2568
    ds_read_b64 v[120:121], v28 offset:3072
    ds_read_b64 v[122:123], v28 offset:3080
    ds_read_b64 v[124:125], v28 offset:3584
    ds_read_b64 v[126:127], v28 offset:3592
    v_lshrrev_b32 v43, 5, v1
    v_lshlrev_b32 v43, 14, v43
    v_and_b32 v44, 31, v1
    v_lshl_add_u32 v43, v44, 7, v43
    s_lshl_b32 s80, s70, 15
    s_add_u32 s26, s80, 5767168
    s_cmp_eq_u32 s2, 0
    s_cbranch_scc1 LEH7
LBH8:
    ds_read_b32 v46, v6 offset:16
    s_waitcnt lgkmcnt(0)
    v_cmp_ne_u32 vcc, 1, v46
    s_nop 1
    s_cbranch_vccnz LSLH11
LOKH9:
    v_mfma_f32_16x16x32_bf16 v[64:67], v[96:99], v[128:131], 0
    ds_read_b64 v[160:161], v28 offset:64
    v_mfma_f32_16x16x32_bf16 v[68:71], v[96:99], v[132:135], 0
    ds_read_b64 v[162:163], v28 offset:72
    v_mfma_f32_16x16x32_bf16 v[72:75], v[96:99], v[136:139], 0
    ds_read_b128 v[192:195], v29 offset:3648
    v_mfma_f32_16x16x32_bf16 v[76:79], v[96:99], v[140:143], 0
    ds_read_b128 v[196:199], v29 offset:3136
    v_mfma_f32_16x16x32_bf16 v[80:83], v[96:99], v[144:147], 0
    ds_read_b128 v[200:203], v29 offset:2624
    v_mfma_f32_16x16x32_bf16 v[84:87], v[96:99], v[148:151], 0
    ds_read_b128 v[204:207], v29 offset:2112
    v_mfma_f32_16x16x32_bf16 v[88:91], v[96:99], v[152:155], 0
    ds_read_b128 v[208:211], v29 offset:1600
    v_mfma_f32_16x16x32_bf16 v[92:95], v[96:99], v[156:159], 0
    ds_read_b128 v[212:215], v29 offset:1088
    v_mfma_f32_16x16x32_bf16 v[68:71], v[100:103], v[128:131], v[68:71]
    ds_read_b128 v[216:219], v29 offset:576
    v_mfma_f32_16x16x32_bf16 v[72:75], v[100:103], v[132:135], v[72:75]
    ds_read_b128 v[220:223], v29 offset:64
    v_mfma_f32_16x16x32_bf16 v[76:79], v[100:103], v[136:139], v[76:79]
    ds_read_b64 v[164:165], v28 offset:576
    v_mfma_f32_16x16x32_bf16 v[80:83], v[100:103], v[140:143], v[80:83]
    ds_read_b64 v[166:167], v28 offset:584
    v_mfma_f32_16x16x32_bf16 v[84:87], v[100:103], v[144:147], v[84:87]
    ds_read_b64 v[168:169], v28 offset:1088
    v_mfma_f32_16x16x32_bf16 v[88:91], v[100:103], v[148:151], v[88:91]
    ds_read_b64 v[170:171], v28 offset:1096
    v_mfma_f32_16x16x32_bf16 v[92:95], v[100:103], v[152:155], v[92:95]
    ds_read_b64 v[172:173], v28 offset:1600
    v_mfma_f32_16x16x32_bf16 v[72:75], v[104:107], v[128:131], v[72:75]
    ds_read_b64 v[174:175], v28 offset:1608
    v_mfma_f32_16x16x32_bf16 v[76:79], v[104:107], v[132:135], v[76:79]
    ds_read_b64 v[176:177], v28 offset:2112
    v_mfma_f32_16x16x32_bf16 v[80:83], v[104:107], v[136:139], v[80:83]
    ds_read_b64 v[178:179], v28 offset:2120
    v_mfma_f32_16x16x32_bf16 v[84:87], v[104:107], v[140:143], v[84:87]
    ds_read_b64 v[180:181], v28 offset:2624
    v_mfma_f32_16x16x32_bf16 v[88:91], v[104:107], v[144:147], v[88:91]
    ds_read_b64 v[182:183], v28 offset:2632
    v_mfma_f32_16x16x32_bf16 v[92:95], v[104:107], v[148:151], v[92:95]
    ds_read_b64 v[184:185], v28 offset:3136
    s_waitcnt vmcnt(0)
    ds_write_b32 v6, v8 offset:48
    v_mfma_f32_16x16x32_bf16 v[76:79], v[108:111], v[128:131], v[76:79]
    ds_read_b64 v[186:187], v28 offset:3144
    v_mfma_f32_16x16x32_bf16 v[80:83], v[108:111], v[132:135], v[80:83]
    ds_read_b64 v[188:189], v28 offset:3648
    v_mfma_f32_16x16x32_bf16 v[84:87], v[108:111], v[136:139], v[84:87]
    ds_read_b64 v[190:191], v28 offset:3656
    v_mfma_f32_16x16x32_bf16 v[88:91], v[108:111], v[140:143], v[88:91]
    v_mfma_f32_16x16x32_bf16 v[92:95], v[108:111], v[144:147], v[92:95]
    v_mfma_f32_16x16x32_bf16 v[80:83], v[112:115], v[128:131], v[80:83]
    v_mfma_f32_16x16x32_bf16 v[84:87], v[112:115], v[132:135], v[84:87]
    v_mfma_f32_16x16x32_bf16 v[88:91], v[112:115], v[136:139], v[88:91]
    v_mfma_f32_16x16x32_bf16 v[92:95], v[112:115], v[140:143], v[92:95]
    v_mfma_f32_16x16x32_bf16 v[84:87], v[116:119], v[128:131], v[84:87]
    v_mfma_f32_16x16x32_bf16 v[88:91], v[116:119], v[132:135], v[88:91]
    v_mfma_f32_16x16x32_bf16 v[92:95], v[116:119], v[136:139], v[92:95]
    v_mfma_f32_16x16x32_bf16 v[88:91], v[120:123], v[128:131], v[88:91]
    v_mfma_f32_16x16x32_bf16 v[92:95], v[120:123], v[132:135], v[92:95]
    v_mfma_f32_16x16x32_bf16 v[92:95], v[124:127], v[128:131], v[92:95]
    s_waitcnt lgkmcnt(15)
    v_mfma_f32_16x16x32_bf16 v[64:67], v[160:163], v[192:195], v[64:67]
    ds_read_b64 v[96:97], v28 offset:128
    v_mfma_f32_16x16x32_bf16 v[68:71], v[160:163], v[196:199], v[68:71]
    ds_read_b64 v[98:99], v28 offset:136
    v_mfma_f32_16x16x32_bf16 v[72:75], v[160:163], v[200:203], v[72:75]
    ds_read_b128 v[128:131], v29 offset:3712
    v_mfma_f32_16x16x32_bf16 v[76:79], v[160:163], v[204:207], v[76:79]
    ds_read_b128 v[132:135], v29 offset:3200
    v_mfma_f32_16x16x32_bf16 v[80:83], v[160:163], v[208:211], v[80:83]
    ds_read_b128 v[136:139], v29 offset:2688
    v_mfma_f32_16x16x32_bf16 v[84:87], v[160:163], v[212:215], v[84:87]
    ds_read_b128 v[140:143], v29 offset:2176
    v_mfma_f32_16x16x32_bf16 v[88:91], v[160:163], v[216:219], v[88:91]
    ds_read_b128 v[144:147], v29 offset:1664
    v_mfma_f32_16x16x32_bf16 v[92:95], v[160:163], v[220:223], v[92:95]
    ds_read_b128 v[148:151], v29 offset:1152
    s_waitcnt lgkmcnt(15)
    v_mfma_f32_16x16x32_bf16 v[68:71], v[164:167], v[192:195], v[68:71]
    ds_read_b128 v[152:155], v29 offset:640
    v_mfma_f32_16x16x32_bf16 v[72:75], v[164:167], v[196:199], v[72:75]
    ds_read_b128 v[156:159], v29 offset:128
    v_mfma_f32_16x16x32_bf16 v[76:79], v[164:167], v[200:203], v[76:79]
    ds_read_b64 v[100:101], v28 offset:640
    v_mfma_f32_16x16x32_bf16 v[80:83], v[164:167], v[204:207], v[80:83]
    ds_read_b64 v[102:103], v28 offset:648
    v_mfma_f32_16x16x32_bf16 v[84:87], v[164:167], v[208:211], v[84:87]
    ds_read_b64 v[104:105], v28 offset:1152
    v_mfma_f32_16x16x32_bf16 v[88:91], v[164:167], v[212:215], v[88:91]
    ds_read_b64 v[106:107], v28 offset:1160
    v_mfma_f32_16x16x32_bf16 v[92:95], v[164:167], v[216:219], v[92:95]
    ds_read_b64 v[108:109], v28 offset:1664
    v_mfma_f32_16x16x32_bf16 v[72:75], v[168:171], v[192:195], v[72:75]
    ds_read_b64 v[110:111], v28 offset:1672
    v_mfma_f32_16x16x32_bf16 v[76:79], v[168:171], v[196:199], v[76:79]
    ds_read_b64 v[112:113], v28 offset:2176
    v_mfma_f32_16x16x32_bf16 v[80:83], v[168:171], v[200:203], v[80:83]
    ds_read_b64 v[114:115], v28 offset:2184
    v_mfma_f32_16x16x32_bf16 v[84:87], v[168:171], v[204:207], v[84:87]
    ds_read_b64 v[116:117], v28 offset:2688
    v_mfma_f32_16x16x32_bf16 v[88:91], v[168:171], v[208:211], v[88:91]
    ds_read_b64 v[118:119], v28 offset:2696
    v_mfma_f32_16x16x32_bf16 v[92:95], v[168:171], v[212:215], v[92:95]
    ds_read_b64 v[120:121], v28 offset:3200
    v_mfma_f32_16x16x32_bf16 v[76:79], v[172:175], v[192:195], v[76:79]
    ds_read_b64 v[122:123], v28 offset:3208
    v_mfma_f32_16x16x32_bf16 v[80:83], v[172:175], v[196:199], v[80:83]
    ds_read_b64 v[124:125], v28 offset:3712
    v_mfma_f32_16x16x32_bf16 v[84:87], v[172:175], v[200:203], v[84:87]
    ds_read_b64 v[126:127], v28 offset:3720
    v_mfma_f32_16x16x32_bf16 v[88:91], v[172:175], v[204:207], v[88:91]
    v_mfma_f32_16x16x32_bf16 v[92:95], v[172:175], v[208:211], v[92:95]
    v_mfma_f32_16x16x32_bf16 v[80:83], v[176:179], v[192:195], v[80:83]
    v_mfma_f32_16x16x32_bf16 v[84:87], v[176:179], v[196:199], v[84:87]
    v_mfma_f32_16x16x32_bf16 v[88:91], v[176:179], v[200:203], v[88:91]
    v_mfma_f32_16x16x32_bf16 v[92:95], v[176:179], v[204:207], v[92:95]
    s_waitcnt lgkmcnt(15)
    v_mfma_f32_16x16x32_bf16 v[84:87], v[180:183], v[192:195], v[84:87]
    v_mfma_f32_16x16x32_bf16 v[88:91], v[180:183], v[196:199], v[88:91]
    v_mfma_f32_16x16x32_bf16 v[92:95], v[180:183], v[200:203], v[92:95]
    v_mfma_f32_16x16x32_bf16 v[88:91], v[184:187], v[192:195], v[88:91]
    v_mfma_f32_16x16x32_bf16 v[92:95], v[184:187], v[196:199], v[92:95]
    v_mfma_f32_16x16x32_bf16 v[92:95], v[188:191], v[192:195], v[92:95]
    v_mfma_f32_16x16x32_bf16 v[64:67], v[96:99], v[128:131], v[64:67]
    ds_read_b64 v[160:161], v28 offset:192
    v_mfma_f32_16x16x32_bf16 v[68:71], v[96:99], v[132:135], v[68:71]
    ds_read_b64 v[162:163], v28 offset:200
    v_mfma_f32_16x16x32_bf16 v[72:75], v[96:99], v[136:139], v[72:75]
    ds_read_b128 v[192:195], v29 offset:3776
    v_mfma_f32_16x16x32_bf16 v[76:79], v[96:99], v[140:143], v[76:79]
    ds_read_b128 v[196:199], v29 offset:3264
    v_mfma_f32_16x16x32_bf16 v[80:83], v[96:99], v[144:147], v[80:83]
    ds_read_b128 v[200:203], v29 offset:2752
    v_mfma_f32_16x16x32_bf16 v[84:87], v[96:99], v[148:151], v[84:87]
    ds_read_b128 v[204:207], v29 offset:2240
    v_mfma_f32_16x16x32_bf16 v[88:91], v[96:99], v[152:155], v[88:91]
    ds_read_b128 v[208:211], v29 offset:1728
    s_waitcnt lgkmcnt(15)
    v_mfma_f32_16x16x32_bf16 v[92:95], v[96:99], v[156:159], v[92:95]
    ds_read_b128 v[212:215], v29 offset:1216
    v_mfma_f32_16x16x32_bf16 v[68:71], v[100:103], v[128:131], v[68:71]
    ds_read_b128 v[216:219], v29 offset:704
    v_mfma_f32_16x16x32_bf16 v[72:75], v[100:103], v[132:135], v[72:75]
    ds_read_b128 v[220:223], v29 offset:192
    v_mfma_f32_16x16x32_bf16 v[76:79], v[100:103], v[136:139], v[76:79]
    ds_read_b64 v[164:165], v28 offset:704
    v_mfma_f32_16x16x32_bf16 v[80:83], v[100:103], v[140:143], v[80:83]
    ds_read_b64 v[166:167], v28 offset:712
    v_mfma_f32_16x16x32_bf16 v[84:87], v[100:103], v[144:147], v[84:87]
    ds_read_b64 v[168:169], v28 offset:1216
    v_mfma_f32_16x16x32_bf16 v[88:91], v[100:103], v[148:151], v[88:91]
    ds_read_b64 v[170:171], v28 offset:1224
    v_mfma_f32_16x16x32_bf16 v[92:95], v[100:103], v[152:155], v[92:95]
    ds_read_b64 v[172:173], v28 offset:1728
    v_mfma_f32_16x16x32_bf16 v[72:75], v[104:107], v[128:131], v[72:75]
    ds_read_b64 v[174:175], v28 offset:1736
    v_mfma_f32_16x16x32_bf16 v[76:79], v[104:107], v[132:135], v[76:79]
    ds_read_b64 v[176:177], v28 offset:2240
    v_mfma_f32_16x16x32_bf16 v[80:83], v[104:107], v[136:139], v[80:83]
    ds_read_b64 v[178:179], v28 offset:2248
    v_mfma_f32_16x16x32_bf16 v[84:87], v[104:107], v[140:143], v[84:87]
    ds_read_b64 v[180:181], v28 offset:2752
    v_mfma_f32_16x16x32_bf16 v[88:91], v[104:107], v[144:147], v[88:91]
    ds_read_b64 v[182:183], v28 offset:2760
    v_mfma_f32_16x16x32_bf16 v[92:95], v[104:107], v[148:151], v[92:95]
    ds_read_b64 v[184:185], v28 offset:3264
    v_mfma_f32_16x16x32_bf16 v[76:79], v[108:111], v[128:131], v[76:79]
    ds_read_b64 v[186:187], v28 offset:3272
    v_mfma_f32_16x16x32_bf16 v[80:83], v[108:111], v[132:135], v[80:83]
    ds_read_b64 v[188:189], v28 offset:3776
    v_mfma_f32_16x16x32_bf16 v[84:87], v[108:111], v[136:139], v[84:87]
    ds_read_b64 v[190:191], v28 offset:3784
    v_mfma_f32_16x16x32_bf16 v[88:91], v[108:111], v[140:143], v[88:91]
    v_mfma_f32_16x16x32_bf16 v[92:95], v[108:111], v[144:147], v[92:95]
    s_waitcnt lgkmcnt(15)
    v_mfma_f32_16x16x32_bf16 v[80:83], v[112:115], v[128:131], v[80:83]
    v_mfma_f32_16x16x32_bf16 v[84:87], v[112:115], v[132:135], v[84:87]
    v_mfma_f32_16x16x32_bf16 v[88:91], v[112:115], v[136:139], v[88:91]
    v_mfma_f32_16x16x32_bf16 v[92:95], v[112:115], v[140:143], v[92:95]
    v_mfma_f32_16x16x32_bf16 v[84:87], v[116:119], v[128:131], v[84:87]
    v_mfma_f32_16x16x32_bf16 v[88:91], v[116:119], v[132:135], v[88:91]
    v_mfma_f32_16x16x32_bf16 v[92:95], v[116:119], v[136:139], v[92:95]
    v_mfma_f32_16x16x32_bf16 v[88:91], v[120:123], v[128:131], v[88:91]
    v_mfma_f32_16x16x32_bf16 v[92:95], v[120:123], v[132:135], v[92:95]
    v_mfma_f32_16x16x32_bf16 v[92:95], v[124:127], v[128:131], v[92:95]
    v_mfma_f32_16x16x32_bf16 v[64:67], v[160:163], v[192:195], v[64:67]
    ds_write_b32 v6, v8 offset:80
    v_mfma_f32_16x16x32_bf16 v[68:71], v[160:163], v[196:199], v[68:71]
    ds_read_b128 v[136:139], v32 offset:1536
    v_mfma_f32_16x16x32_bf16 v[72:75], v[160:163], v[200:203], v[72:75]
    ds_read_b128 v[140:143], v32 offset:1024
    v_mfma_f32_16x16x32_bf16 v[76:79], v[160:163], v[204:207], v[76:79]
    ds_read_b128 v[144:147], v32 offset:512
    v_mfma_f32_16x16x32_bf16 v[80:83], v[160:163], v[208:211], v[80:83]
    ds_read_b128 v[148:151], v32 offset:0
    v_mfma_f32_16x16x32_bf16 v[84:87], v[160:163], v[212:215], v[84:87]
    v_mfma_f32_16x16x32_bf16 v[88:91], v[160:163], v[216:219], v[88:91]
    s_waitcnt lgkmcnt(15)
    v_mfma_f32_16x16x32_bf16 v[92:95], v[160:163], v[220:223], v[92:95]
    v_mfma_f32_16x16x32_bf16 v[68:71], v[164:167], v[192:195], v[68:71]
    s_waitcnt lgkmcnt(0)
    v_lshlrev_b32 v104, 16, v139
    v_mfma_f32_16x16x32_bf16 v[72:75], v[164:167], v[196:199], v[72:75]
    v_lshlrev_b32 v105, 16, v138
    v_mfma_f32_16x16x32_bf16 v[76:79], v[164:167], v[200:203], v[76:79]
    v_lshlrev_b32 v106, 16, v137
    v_mfma_f32_16x16x32_bf16 v[80:83], v[164:167], v[204:207], v[80:83]
    v_lshlrev_b32 v107, 16, v136
    v_mfma_f32_16x16x32_bf16 v[84:87], v[164:167], v[208:211], v[84:87]
    v_lshlrev_b32 v108, 16, v143
    v_mfma_f32_16x16x32_bf16 v[88:91], v[164:167], v[212:215], v[88:91]
    v_lshlrev_b32 v109, 16, v142
    v_mfma_f32_16x16x32_bf16 v[92:95], v[164:167], v[216:219], v[92:95]
    v_lshlrev_b32 v110, 16, v141
    v_mfma_f32_16x16x32_bf16 v[72:75], v[168:171], v[192:195], v[72:75]
    v_lshlrev_b32 v111, 16, v140
    v_mfma_f32_16x16x32_bf16 v[76:79], v[168:171], v[196:199], v[76:79]
    v_lshlrev_b32 v112, 16, v147
    v_mfma_f32_16x16x32_bf16 v[80:83], v[168:171], v[200:203], v[80:83]
    v_lshlrev_b32 v113, 16, v146
    v_mfma_f32_16x16x32_bf16 v[84:87], v[168:171], v[204:207], v[84:87]
    v_lshlrev_b32 v114, 16, v145
    v_mfma_f32_16x16x32_bf16 v[88:91], v[168:171], v[208:211], v[88:91]
    v_lshlrev_b32 v115, 16, v144
    v_mfma_f32_16x16x32_bf16 v[92:95], v[168:171], v[212:215], v[92:95]
    v_lshlrev_b32 v116, 16, v151
    v_mfma_f32_16x16x32_bf16 v[76:79], v[172:175], v[192:195], v[76:79]
    v_lshlrev_b32 v117, 16, v150
    v_mfma_f32_16x16x32_bf16 v[80:83], v[172:175], v[196:199], v[80:83]
    v_lshlrev_b32 v118, 16, v149
    v_mfma_f32_16x16x32_bf16 v[84:87], v[172:175], v[200:203], v[84:87]
    v_lshlrev_b32 v119, 16, v148
    v_mfma_f32_16x16x32_bf16 v[88:91], v[172:175], v[204:207], v[88:91]
    v_mfma_f32_16x16x32_bf16 v[92:95], v[172:175], v[208:211], v[92:95]
    v_mfma_f32_16x16x32_bf16 v[80:83], v[176:179], v[192:195], v[80:83]
    v_mfma_f32_16x16x32_bf16 v[84:87], v[176:179], v[196:199], v[84:87]
    v_mfma_f32_16x16x32_bf16 v[88:91], v[176:179], v[200:203], v[88:91]
    v_mfma_f32_16x16x32_bf16 v[92:95], v[176:179], v[204:207], v[92:95]
    v_mfma_f32_16x16x32_bf16 v[84:87], v[180:183], v[192:195], v[84:87]
    ds_read_b32 v47, v9 offset:80
    v_mfma_f32_16x16x32_bf16 v[88:91], v[180:183], v[196:199], v[88:91]
    v_mfma_f32_16x16x32_bf16 v[92:95], v[180:183], v[200:203], v[92:95]
    v_mfma_f32_16x16x32_bf16 v[88:91], v[184:187], v[192:195], v[88:91]
    v_mfma_f32_16x16x32_bf16 v[92:95], v[184:187], v[196:199], v[92:95]
    v_mfma_f32_16x16x32_bf16 v[92:95], v[188:191], v[192:195], v[92:95]
    s_waitcnt lgkmcnt(0)
    v_cmp_ne_u32 vcc, 1, v47
    s_nop 1
    s_cbranch_vccnz LSLH14
LOKH12:
    s_cmp_lg_u32 s3, 0
    s_nop 4
    s_cbranch_scc1 LOH15
    ds_write_b128 v30, v[80:83] offset:0
    ds_write_b128 v30, v[84:87] offset:1024
    ds_write_b128 v30, v[88:91] offset:2048
    ds_write_b128 v30, v[92:95] offset:3072
    ds_write_b32 v6, v8 offset:96
    v_fma_f32 v120, v104, v34, v64
    v_fma_f32 v121, v105, v34, v65
    v_fma_f32 v122, v106, v34, v66
    v_fma_f32 v123, v107, v34, v67
    v_fma_f32 v124, v108, v34, v68
    v_fma_f32 v125, v109, v34, v69
    v_fma_f32 v126, v110, v34, v70
    v_fma_f32 v127, v111, v34, v71
    v_fma_f32 v128, v112, v34, v72
    v_fma_f32 v129, v113, v34, v73
    v_fma_f32 v130, v114, v34, v74
    v_fma_f32 v131, v115, v34, v75
    v_fma_f32 v132, v116, v34, v76
    v_fma_f32 v133, v117, v34, v77
    v_fma_f32 v134, v118, v34, v78
    v_fma_f32 v135, v119, v34, v79
    s_branch LJH16
LOH15:
    ds_write_b128 v30, v[64:67] offset:0
    ds_write_b128 v30, v[68:71] offset:1024
    ds_write_b128 v30, v[72:75] offset:2048
    ds_write_b128 v30, v[76:79] offset:3072
    ds_write_b32 v6, v8 offset:96
    v_fma_f32 v120, v104, v34, v80
    v_fma_f32 v121, v105, v34, v81
    v_fma_f32 v122, v106, v34, v82
    v_fma_f32 v123, v107, v34, v83
    v_fma_f32 v124, v108, v34, v84
    v_fma_f32 v125, v109, v34, v85
    v_fma_f32 v126, v110, v34, v86
    v_fma_f32 v127, v111, v34, v87
    v_fma_f32 v128, v112, v34, v88
    v_fma_f32 v129, v113, v34, v89
    v_fma_f32 v130, v114, v34, v90
    v_fma_f32 v131, v115, v34, v91
    v_fma_f32 v132, v116, v34, v92
    v_fma_f32 v133, v117, v34, v93
    v_fma_f32 v134, v118, v34, v94
    v_fma_f32 v135, v119, v34, v95
LJH16:
    ds_read_b32 v46, v9 offset:96
    s_waitcnt lgkmcnt(0)
    v_cmp_ne_u32 vcc, 1, v46
    s_nop 1
    s_cbranch_vccnz LSLH19
LOKH17:
    ds_read_b128 v[136:139], v31 offset:0
    ds_read_b128 v[140:143], v31 offset:1024
    ds_read_b128 v[144:147], v31 offset:2048
    ds_read_b128 v[148:151], v31 offset:3072
    ds_write_b32 v6, v8 offset:176
    s_waitcnt lgkmcnt(3)
    v_add_f32 v120, v120, v136
    v_add_f32 v121, v121, v137
    v_add_f32 v122, v122, v138
    v_add_f32 v123, v123, v139
    v_add_f32 v124, v124, v140
    v_add_f32 v125, v125, v141
    v_add_f32 v126, v126, v142
    v_add_f32 v127, v127, v143
    v_cvt_pk_bf16_f32 v152, v120, v121
    v_cvt_pk_bf16_f32 v153, v122, v123
    v_cvt_pk_bf16_f32 v154, v124, v125
    v_cvt_pk_bf16_f32 v155, v126, v127
    s_nop 0
    v_permlane16_swap_b32 v152, v154
    v_permlane16_swap_b32 v153, v155
    buffer_store_dwordx4 v[152:155], v33, s[56:59], s21 offen offset:0 sc1
    s_waitcnt lgkmcnt(1)
    v_add_f32 v128, v128, v144
    v_add_f32 v129, v129, v145
    v_add_f32 v130, v130, v146
    v_add_f32 v131, v131, v147
    v_add_f32 v132, v132, v148
    v_add_f32 v133, v133, v149
    v_add_f32 v134, v134, v150
    v_add_f32 v135, v135, v151
    v_cvt_pk_bf16_f32 v156, v128, v129
    v_cvt_pk_bf16_f32 v157, v130, v131
    v_cvt_pk_bf16_f32 v158, v132, v133
    v_cvt_pk_bf16_f32 v159, v134, v135
    s_nop 0
    v_permlane16_swap_b32 v156, v158
    v_permlane16_swap_b32 v157, v159
    buffer_store_dwordx4 v[156:159], v33, s[56:59], s21 offen offset:1024 sc1
    buffer_load_dwordx4 v[244:247], v35, s[28:31], s25 offen
    buffer_load_dwordx4 v[248:251], v36, s[28:31], s25 offen
    ds_read_b32 v46, v7 offset:176
    s_waitcnt lgkmcnt(0)
    v_cmp_ne_u32 vcc, 1, v46
    s_nop 1
    s_cbranch_vccnz LSLH22
LOKH20:
    s_add_u32 s84, s84, 65536
    s_cmp_ge_u32 s84, s86
    s_cselect_b32 s84, s85, s84
    s_add_u32 s84, s84, 65536
    s_cmp_ge_u32 s84, s86
    s_cselect_b32 s84, s85, s84
    s_add_u32 s84, s84, 65536
    s_cmp_ge_u32 s84, s86
    s_cselect_b32 s84, s85, s84
    s_add_u32 s84, s84, 65536
    s_cmp_ge_u32 s84, s86
    s_cselect_b32 s84, s85, s84
    s_add_u32 s84, s84, 65536
    s_cmp_ge_u32 s84, s86
    s_cselect_b32 s84, s85, s84
    s_add_u32 s84, s84, 65536
    s_cmp_ge_u32 s84, s86
    s_cselect_b32 s84, s85, s84
    s_add_u32 s84, s84, 65536
    s_cmp_ge_u32 s84, s86
    s_cselect_b32 s84, s85, s84
    s_add_u32 s84, s84, 65536
    s_cmp_ge_u32 s84, s86
    s_cselect_b32 s84, s85, s84
    s_add_u32 m0, s79, 125696
    s_nop 0
    buffer_load_dwordx4 v17, s[48:51], s84 offen lds
    s_add_u32 m0, s79, 129792
    s_nop 0
    buffer_load_dwordx4 v18, s[48:51], s84 offen lds
    s_add_u32 m0, s79, 133888
    s_nop 0
    buffer_load_dwordx4 v19, s[48:51], s84 offen lds
    s_waitcnt vmcnt(5)
    s_mov_b32 exec_hi, 0
    buffer_store_dword v3, v0, s[56:59], s20 offen sc1
    s_mov_b32 exec_hi, -1
    s_waitcnt vmcnt(1)
    ds_write_b32 v6, v8 offset:128
    ds_read_b64 v[104:105], v41
    ds_read_b64 v[106:107], v41 offset:64
    v_mov_b32 v144, 0
    v_mov_b32 v145, 0
    v_mov_b32 v146, 0
    v_mov_b32 v147, 0
    v_mov_b32 v148, 0
    v_mov_b32 v149, 0
    v_mov_b32 v150, 0
    v_mov_b32 v151, 0
    v_mov_b32 v152, 0
    v_mov_b32 v153, 0
    v_mov_b32 v154, 0
    v_mov_b32 v155, 0
    v_mov_b32 v156, 0
    v_mov_b32 v157, 0
    v_mov_b32 v158, 0
    v_mov_b32 v159, 0
    s_cmp_eq_u32 s2, 0
    s_cbranch_scc1 LEH23
LBH24:
    s_waitcnt lgkmcnt(0)
    v_mul_f32 v108, v104, v105
    v_mul_f32 v109, v106, v107
    v_lshlrev_b32 v112, 16, v244
    v_and_b32 v113, 0xffff0000, v244
    v_lshlrev_b32 v114, 16, v245
    v_and_b32 v115, 0xffff0000, v245
    v_lshlrev_b32 v116, 16, v246
    v_and_b32 v117, 0xffff0000, v246
    v_lshlrev_b32 v118, 16, v247
    v_and_b32 v119, 0xffff0000, v247
    v_lshlrev_b32 v120, 16, v248
    v_and_b32 v121, 0xffff0000, v248
    v_lshlrev_b32 v122, 16, v249
    v_and_b32 v123, 0xffff0000, v249
    v_lshlrev_b32 v124, 16, v250
    v_and_b32 v125, 0xffff0000, v250
    v_lshlrev_b32 v126, 16, v251
    v_and_b32 v127, 0xffff0000, v251
    v_fma_f32 v128, v112, v105, -v108
    v_fma_f32 v129, v113, v105, -v108
    v_fma_f32 v130, v114, v105, -v108
    v_fma_f32 v131, v115, v105, -v108
    v_fma_f32 v132, v116, v105, -v108
    v_fma_f32 v133, v117, v105, -v108
    v_fma_f32 v134, v118, v105, -v108
    v_fma_f32 v135, v119, v105, -v108
    v_fma_f32 v136, v120, v107, -v109
    v_fma_f32 v137, v121, v107, -v109
    v_fma_f32 v138, v122, v107, -v109
    v_fma_f32 v139, v123, v107, -v109
    v_fma_f32 v140, v124, v107, -v109
    v_fma_f32 v141, v125, v107, -v109
    v_fma_f32 v142, v126, v107, -v109
    v_fma_f32 v143, v127, v107, -v109
    ds_read_b32 v46, v6 offset:192
    s_waitcnt lgkmcnt(0)
    v_cmp_ne_u32 vcc, 1, v46
    s_nop 1
    s_cbranch_vccnz LSLH32
LOKH30:
    buffer_load_dword v4, v5, s[56:59], s18 offen sc1
    s_waitcnt vmcnt(0)
    v_cmp_ne_u32 vcc, s74, v4
    s_nop 1
    s_cbranch_vccnz LSLOWH35
LOKH33:
    buffer_load_dwordx4 v[160:163], v23, s[56:59], s23 offen sc1
    buffer_load_dwordx4 v[164:167], v24, s[56:59], s23 offen sc1
    ds_read_b32 v46, v7 offset:208
    s_waitcnt lgkmcnt(0)
    v_cmp_ne_u32 vcc, 1, v46
    s_nop 1
    s_cbranch_vccnz LSLH38
LOKH36:
    s_waitcnt vmcnt(0)
    ds_write_b128 v37, v[160:163]
    ds_write_b128 v38, v[164:167] offset:1024
    ds_write_b32 v6, v8 offset:144
    ds_read_b32 v46, v7 offset:144
    s_waitcnt lgkmcnt(0)
    v_cmp_ne_u32 vcc, 1, v46
    s_nop 1
    s_cbranch_vccnz LSLH41
LOKH39:
    ds_read_u16_d16_hi v144, v39 offset:0
    ds_read_u16_d16_hi v145, v39 offset:128
    ds_read_u16_d16_hi v146, v39 offset:256
    ds_read_u16_d16_hi v147, v39 offset:384
    ds_read_u16_d16_hi v148, v39 offset:512
    ds_read_u16_d16_hi v149, v39 offset:640
    ds_read_u16_d16_hi v150, v39 offset:768
    ds_read_u16_d16_hi v151, v39 offset:896
    ds_read_u16_d16_hi v152, v39 offset:8
    ds_read_u16_d16_hi v153, v39 offset:136
    ds_read_u16_d16_hi v154, v39 offset:264
    ds_read_u16_d16_hi v155, v39 offset:392
    ds_read_u16_d16_hi v156, v39 offset:520
    ds_read_u16_d16_hi v157, v39 offset:648
    ds_read_u16_d16_hi v158, v39 offset:776
    ds_read_u16_d16_hi v159, v39 offset:904
    s_waitcnt lgkmcnt(0)
    v_fmac_f32 v112, v128, v144
    v_fmac_f32 v113, v129, v145
    v_fmac_f32 v114, v130, v146
    v_fmac_f32 v115, v131, v147
    v_fmac_f32 v116, v132, v148
    v_fmac_f32 v117, v133, v149
    v_fmac_f32 v118, v134, v150
    v_fmac_f32 v119, v135, v151
    v_fmac_f32 v120, v136, v152
    v_fmac_f32 v121, v137, v153
    v_fmac_f32 v122, v138, v154
    v_fmac_f32 v123, v139, v155
    v_fmac_f32 v124, v140, v156
    v_fmac_f32 v125, v141, v157
    v_fmac_f32 v126, v142, v158
    v_fmac_f32 v127, v143, v159
    s_barrier
    ds_read_b128 v[176:179], v42 offset:0
    ds_read_b128 v[180:183], v42 offset:16
    ds_read_b128 v[184:187], v42 offset:17408
    ds_read_b128 v[188:191], v42 offset:17424
    ds_read_b128 v[192:195], v42 offset:2176
    ds_read_b128 v[196:199], v42 offset:2192
    ds_read_b128 v[200:203], v42 offset:19584
    ds_read_b128 v[204:207], v42 offset:19600
    s_waitcnt lgkmcnt(4)
    v_pk_add_f32 v[176:177], v[176:177], v[184:185]
    v_pk_add_f32 v[178:179], v[178:179], v[186:187]
    v_pk_add_f32 v[180:181], v[180:181], v[188:189]
    v_pk_add_f32 v[182:183], v[182:183], v[190:191]
    v_pk_add_f32 v[176:177], v[176:177], v[112:113]
    v_pk_add_f32 v[178:179], v[178:179], v[114:115]
    v_pk_add_f32 v[180:181], v[180:181], v[116:117]
    v_pk_add_f32 v[182:183], v[182:183], v[118:119]
    v_cvt_pk_bf16_f32 v208, v176, v177
    v_cvt_pk_bf16_f32 v209, v178, v179
    v_cvt_pk_bf16_f32 v210, v180, v181
    v_cvt_pk_bf16_f32 v211, v182, v183
    buffer_store_dwordx4 v[208:211], v35, s[64:67], s25 offen sc1
    s_waitcnt lgkmcnt(0)
    v_pk_add_f32 v[192:193], v[192:193], v[200:201]
    v_pk_add_f32 v[194:195], v[194:195], v[202:203]
    v_pk_add_f32 v[196:197], v[196:197], v[204:205]
    v_pk_add_f32 v[198:199], v[198:199], v[206:207]
    v_pk_add_f32 v[192:193], v[192:193], v[120:121]
    v_pk_add_f32 v[194:195], v[194:195], v[122:123]
    v_pk_add_f32 v[196:197], v[196:197], v[124:125]
    v_pk_add_f32 v[198:199], v[198:199], v[126:127]
    v_cvt_pk_bf16_f32 v212, v192, v193
    v_cvt_pk_bf16_f32 v213, v194, v195
    v_cvt_pk_bf16_f32 v214, v196, v197
    v_cvt_pk_bf16_f32 v215, v198, v199
    buffer_store_dwordx4 v[212:215], v36, s[64:67], s25 offen sc1
    s_endpgm
LC:
    s_mov_b64 exec, -1
    s_setprio 1
    s_load_dwordx2 s[60:61], s[0:1], 88
    s_load_dwordx2 s[52:53], s[0:1], 32
    s_load_dwordx2 s[14:15], s[0:1], 40
    s_load_dwordx2 s[48:49], s[0:1], 64
    s_load_dwordx2 s[64:65], s[0:1], 72
    s_and_b32 s73, s68, 1
    s_and_b32 s72, s69, 7
    s_lshr_b32 s80, s69, 3
    s_lshr_b32 s71, s68, 1
    s_lshl_b32 s71, s71, 2
    s_add_u32 s71, s71, s80
    s_add_u32 s76, s80, s72
    s_and_b32 s76, s76, 3
    s_mul_i32 s75, s73, 22
    s_mul_i32 s81, s72, 3
    s_add_u32 s75, s75, s81
    s_add_u32 s81, s72, s73
    s_max_u32 s82, s81, 6
    s_sub_u32 s82, s82, 6
    s_sub_u32 s75, s75, s82
    s_cmp_lt_u32 s81, 6
    s_cselect_b32 s46, 1409024, 0
    s_cselect_b32 s62, 16777216, 0
    s_and_b32 s3, s70, 1
    s_lshr_b32 s27, s70, 1
    s_mov_b32 s59, s35
    s_mov_b32 s58, 16777216
    v_lshlrev_b32 v0, 2, v1
    v_lshlrev_b32 v2, 4, v1
    v_lshrrev_b32 v5, 2, v1
    v_lshlrev_b32 v5, 7, v5
    v_mov_b32 v8, 1
    s_lshl_b32 s80, s70, 2
    s_add_u32 s80, s80, 122880
    v_mov_b32 v6, s80
    v_and_b32 v7, 3, v1
    v_lshlrev_b32 v7, 2, v7
    v_add_u32 v7, 122880, v7
    s_mov_b32 s63, s35
    v_and_b32 v20, 16, v1
    v_lshlrev_b32 v20, 1, v20
    v_and_b32 v21, 3, v1
    v_lshl_add_u32 v25, v21, 3, v20
    v_lshrrev_b32 v20, 5, v1
    v_bfe_u32 v21, v1, 2, 2
    v_lshl_add_u32 v22, v20, 3, v21
    v_lshl_add_u32 v22, v22, 6, v25
    v_and_b32 v23, 31, v1
    v_lshlrev_b32 v23, 7, v23
    s_add_u32 s80, s91, 3072
    v_add_u32 v23, s80, v23
    v_bfe_u32 v24, v1, 1, 3
    v_xor_b32 v24, v24, v20
    v_lshl_add_u32 v23, v24, 4, v23
    s_add_u32 s80, s70, 0
    s_and_b32 s80, s80, 3
    s_mul_i32 s81, s80, 7168
    s_lshl_b32 s80, s80, 5
    v_add_u32 v228, s81, v22
    v_xor_b32 v220, s80, v23
    v_add_u32 v232, 57344, v228
    v_add_u32 v224, 57344, v220
    s_add_u32 s80, s70, 1
    s_and_b32 s80, s80, 3
    s_mul_i32 s81, s80, 7168
    s_lshl_b32 s80, s80, 5
    v_add_u32 v229, s81, v22
    v_xor_b32 v221, s80, v23
    v_add_u32 v233, 57344, v229
    v_add_u32 v225, 57344, v221
    s_add_u32 s80, s70, 2
    s_and_b32 s80, s80, 3
    s_mul_i32 s81, s80, 7168
    s_lshl_b32 s80, s80, 5
    v_add_u32 v230, s81, v22
    v_xor_b32 v222, s80, v23
    v_add_u32 v234, 57344, v230
    v_add_u32 v226, 57344, v222
    s_add_u32 s80, s70, 3
    s_and_b32 s80, s80, 3
    s_mul_i32 s81, s80, 7168
    s_lshl_b32 s80, s80, 5
    v_add_u32 v231, s81, v22
    v_xor_b32 v223, s80, v23
    v_add_u32 v235, 57344, v231
    v_add_u32 v227, 57344, v223
    v_lshrrev_b32 v22, 4, v1
    v_xor_b32 v22, v22, v1
    v_and_b32 v22, 1, v22
    v_cmp_eq_u32 vcc, 0, v22
    v_mov_b32 v23, 0x3f803f80
    v_mov_b32 v56, 0
    v_cndmask_b32 v36, 0, v23, vcc
    v_mov_b32 v37, v36
    v_mov_b32 v57, 0
    v_mov_b32 v38, v36
    v_mov_b32 v58, 0
    v_mov_b32 v39, v36
    v_mov_b32 v59, 0
    v_lshl_add_u32 v22, v20, 2, v21
    v_lshl_add_u32 v22, v22, 7, v25
    v_and_b32 v23, 8, v1
    v_lshl_add_u32 v22, v23, 3, v22
    s_mul_i32 s80, s27, 2112
    v_xor_b32 v10, s80, v22
    v_xor_b32 v11, 64, v10
    v_add_u32 v12, 49152, v10
    v_add_u32 v13, 49152, v11
    v_add_u32 v14, 98304, v10
    v_add_u32 v15, 98304, v11
    s_mov_b32 s51, s35
    s_mov_b32 s50, 1409024
    s_lshl_b32 s79, s70, 10
    v_lshrrev_b32 v22, 3, v1
    v_lshlrev_b32 v22, 10, v22
    v_and_b32 v23, 7, v1
    v_lshl_add_u32 v22, v23, 4, v22
    s_lshl_b32 s80, s3, 13
    s_lshl_b32 s81, s72, 7
    s_add_u32 s80, s80, s81
    v_and_b32 v23, 16, v1
    v_lshlrev_b32 v23, 2, v23
    v_xor_b32 v22, v22, v23
    v_add_u32 v248, s80, v22
    v_add_u32 v249, 16384, v248
    v_add_u32 v250, 32768, v248
    v_add_u32 v251, 49152, v248
    s_and_b32 s81, s71, 3
    s_mul_i32 s81, s81, 5
    s_add_u32 s81, s81, 1
    s_lshr_b32 s81, s81, 1
    s_add_u32 s80, s72, s81
    s_sub_u32 s81, s80, 10
    s_min_u32 s80, s80, s81
    s_mul_i32 s81, s27, 43
    s_lshl_b32 s85, s81, 14
    s_add_u32 s86, s85, 655360
    s_lshl_b32 s82, s80, 16
    s_add_u32 s84, s85, s82
    s_add_u32 s84, s84, 65536
    s_cmp_ge_u32 s84, s86
    s_cselect_b32 s84, s85, s84
    s_lshl_b32 s82, s71, 2
    s_lshl_b32 s83, s73, 1
    s_add_u32 s83, s82, s83
    s_add_u32 s9, s83, s3
    s_mul_i32 s83, s9, 87
    s_add_u32 s83, s83, s81
    s_lshl_b32 s88, s83, 10
    s_add_u32 s89, s88, 40960
    s_lshl_b32 s83, s80, 12
    s_add_u32 s87, s88, s83
    s_add_u32 s82, s82, s70
    s_mul_i32 s83, s82, 87
    s_lshl_b32 s80, s75, 1
    s_add_u32 s83, s83, s80
    s_lshl_b32 s92, s83, 10
    s_add_u32 s93, s92, 4096
    s_lshl_b32 s82, s82, 4
    s_lshl_b32 s83, s73, 3
    s_add_u32 s82, s82, s83
    s_add_u32 s82, s82, s72
    s_lshl_b32 s82, s82, 7
    s_add_u32 s19, s82, 5898240
    s_lshl_b32 s82, s9, 11
    s_add_u32 s17, s82, 5898240
    v_and_b32 v22, 31, v1
    v_lshlrev_b32 v23, 4, v22
    v_add_u32 v27, 123136, v23
    s_lshl_b32 s80, s70, 2
    v_add_u32 v26, s80, v27
    s_lshl_b32 s80, s70, 8
    s_add_u32 s80, s80, 124672
    v_lshl_add_u32 v28, v22, 3, s80
    s_mul_i32 s80, s70, 8704
    s_add_u32 s80, s80, 45056
    v_mul_u32_u24 v23, 272, v22
    v_lshl_add_u32 v23, v20, 4, v23
    s_lshl_b32 s81, s27, 7
    s_add_u32 s82, s80, s81
    v_add_u32 v16, s82, v23
    s_xor_b32 s81, s81, 128
    s_add_u32 s82, s80, s81
    v_add_u32 v17, s82, v23
    s_waitcnt lgkmcnt(0)
    s_add_u32 s6, s56, 6160384
    s_addc_u32 s7, s57, 0
    s_load_dword s74, s[6:7], 0
    s_waitcnt lgkmcnt(0)
    s_mul_i32 s74, s74, 1664525
    s_add_u32 s74, s74, 1013904223
    v_mov_b32 v3, s74
    s_cmp_eq_u32 s27, s73
    s_cselect_b32 s77, 1, 0
    v_lshrrev_b32 v21, 2, v1
    v_and_b32 v22, 7, v21
    v_max_u32 v21, 7, v21
    s_cmp_eq_u32 s27, 0
    s_cselect_b64 vcc, -1, 0
    v_cndmask_b32 v5, v21, v22, vcc
    v_lshlrev_b32 v5, 7, v5
    v_not_b32 v21, v3
    s_mov_b32 exec_hi, 0
    buffer_store_dword v21, v0, s[56:59], s19 offen sc1
    s_mov_b32 exec_hi, -1
    v_and_b32 v20, 16, v1
    v_cmp_ne_u32 vcc, 0, v20
    s_barrier
    s_cmp_lg_u32 s62, 0
    s_cbranch_scc1 LMC1
    s_mul_i32 s80, s71, 5
    s_mul_i32 s81, s73, 3
    s_add_u32 s80, s80, s81
    s_add_u32 s80, s80, s72
    s_sub_u32 s80, s80, 6
    s_lshl_b32 s80, s80, 2
    s_add_u32 s80, s80, s70
    s_lshl_b32 s80, s80, 10
    v_add_u32 v180, s80, v2
    buffer_load_dwordx4 v[196:199], v180, s[48:51], 0 offen
    v_add_u32 v180, 327680, v180
    buffer_load_dwordx4 v[200:203], v180, s[48:51], 0 offen
    v_add_u32 v180, 327680, v180
    buffer_load_dwordx4 v[204:207], v180, s[48:51], 0 offen
    v_add_u32 v180, 327680, v180
    buffer_load_dwordx4 v[208:211], v180, s[48:51], 0 offen
    v_add_u32 v180, 327680, v180
    buffer_load_dwordx4 v[212:215], v180, s[48:51], 0 offen
    v_add_u32 v180, 327680, v180
LMC1:
    s_barrier
    ds_read_b128 v[112:115], v220 offset:0
    ds_read_b128 v[116:119], v221 offset:0
    ds_read_b128 v[120:123], v222 offset:0
    ds_read_b128 v[124:127], v223 offset:0
    ds_read_b64_tr_b16 v[144:145], v228 offset:0
    ds_read_b64_tr_b16 v[146:147], v228 offset:256
    ds_read_b64_tr_b16 v[148:149], v228 offset:1024
    ds_read_b64_tr_b16 v[150:151], v228 offset:1280
    ds_read_b64_tr_b16 v[152:153], v228 offset:2048
    ds_read_b64_tr_b16 v[154:155], v228 offset:2304
    ds_read_b64_tr_b16 v[156:157], v229 offset:0
    ds_read_b64_tr_b16 v[158:159], v229 offset:256
    ds_read_b64_tr_b16 v[160:161], v229 offset:1024
    ds_read_b64_tr_b16 v[162:163], v229 offset:1280
    ds_read_b64_tr_b16 v[164:165], v229 offset:2048
    ds_read_b64_tr_b16 v[166:167], v229 offset:2304
    s_waitcnt lgkmcnt(12)
    s_waitcnt lgkmcnt(10)
    v_mfma_f32_32x32x16_bf16 v[64:79], v[144:147], v[112:115], 0
    ds_read_b64_tr_b16 v[168:169], v230 offset:0
    ds_read_b64_tr_b16 v[170:171], v230 offset:256
    s_waitcnt lgkmcnt(10)
    v_mfma_f32_32x32x16_bf16 v[80:95], v[148:151], v[112:115], 0
    ds_read_b64_tr_b16 v[172:173], v230 offset:1024
    ds_read_b64_tr_b16 v[174:175], v230 offset:1280
    s_waitcnt lgkmcnt(10)
    v_mfma_f32_32x32x16_bf16 v[96:111], v[152:155], v[112:115], 0
    ds_read_b64_tr_b16 v[176:177], v230 offset:2048
    ds_read_b64_tr_b16 v[178:179], v230 offset:2304
    v_mfma_f32_16x16x32_bf16 v[40:43], v[36:39], v[112:115], 0
    v_mfma_f32_16x16x32_bf16 v[44:47], v[36:39], v[144:147], 0
    v_mfma_f32_16x16x32_bf16 v[48:51], v[36:39], v[148:151], 0
    v_mfma_f32_16x16x32_bf16 v[52:55], v[36:39], v[152:155], 0
    s_waitcnt lgkmcnt(10)
    v_mfma_f32_32x32x16_bf16 v[64:79], v[156:159], v[116:119], v[64:79]
    ds_read_b64_tr_b16 v[144:145], v231 offset:0
    ds_read_b64_tr_b16 v[146:147], v231 offset:256
    s_waitcnt lgkmcnt(10)
    v_mfma_f32_32x32x16_bf16 v[80:95], v[160:163], v[116:119], v[80:95]
    ds_read_b64_tr_b16 v[148:149], v231 offset:1024
    ds_read_b64_tr_b16 v[150:151], v231 offset:1280
    s_waitcnt lgkmcnt(10)
    v_mfma_f32_32x32x16_bf16 v[96:111], v[164:167], v[116:119], v[96:111]
    ds_read_b64_tr_b16 v[152:153], v231 offset:2048
    ds_read_b64_tr_b16 v[154:155], v231 offset:2304
    v_mfma_f32_16x16x32_bf16 v[40:43], v[36:39], v[116:119], v[40:43]
    v_dot2c_f32_bf16 v56, v112, v112
    v_dot2c_f32_bf16 v57, v113, v113
    v_dot2c_f32_bf16 v58, v114, v114
    v_dot2c_f32_bf16 v59, v115, v115
    v_dot2c_f32_bf16 v56, v116, v116
    v_dot2c_f32_bf16 v57, v117, v117
    v_dot2c_f32_bf16 v58, v118, v118
    v_dot2c_f32_bf16 v59, v119, v119
    v_dot2c_f32_bf16 v56, v120, v120
    v_dot2c_f32_bf16 v57, v121, v121
    v_dot2c_f32_bf16 v58, v122, v122
    v_dot2c_f32_bf16 v59, v123, v123
    v_dot2c_f32_bf16 v56, v124, v124
    v_dot2c_f32_bf16 v57, v125, v125
    v_dot2c_f32_bf16 v58, v126, v126
    v_dot2c_f32_bf16 v59, v127, v127
    s_waitcnt lgkmcnt(0)
    s_barrier
    v_mfma_f32_32x32x16_bf16 v[64:79], v[168:171], v[120:123], v[64:79]
    ds_read_b128 v[128:131], v220 offset:28672
    ds_read_b128 v[132:135], v221 offset:28672
    ds_read_b128 v[136:139], v222 offset:28672
    v_mfma_f32_32x32x16_bf16 v[80:95], v[172:175], v[120:123], v[80:95]
    ds_read_b128 v[140:143], v223 offset:28672
    ds_read_b64_tr_b16 v[156:157], v228 offset:28672
    ds_read_b64_tr_b16 v[158:159], v228 offset:28928
    v_mfma_f32_32x32x16_bf16 v[96:111], v[176:179], v[120:123], v[96:111]
    ds_read_b64_tr_b16 v[160:161], v228 offset:29696
    ds_read_b64_tr_b16 v[162:163], v228 offset:29952
    ds_read_b64_tr_b16 v[164:165], v228 offset:30720
    v_mfma_f32_16x16x32_bf16 v[40:43], v[36:39], v[120:123], v[40:43]
    ds_read_b64_tr_b16 v[166:167], v228 offset:30976
    v_mfma_f32_32x32x16_bf16 v[64:79], v[144:147], v[124:127], v[64:79]
    ds_read_b64_tr_b16 v[168:169], v229 offset:28672
    ds_read_b64_tr_b16 v[170:171], v229 offset:28928
    v_mfma_f32_32x32x16_bf16 v[80:95], v[148:151], v[124:127], v[80:95]
    ds_read_b64_tr_b16 v[172:173], v229 offset:29696
    ds_read_b64_tr_b16 v[174:175], v229 offset:29952
    v_mfma_f32_32x32x16_bf16 v[96:111], v[152:155], v[124:127], v[96:111]
    ds_read_b64_tr_b16 v[176:177], v229 offset:30720
    ds_read_b64_tr_b16 v[178:179], v229 offset:30976
    v_mfma_f32_16x16x32_bf16 v[40:43], v[36:39], v[124:127], v[40:43]
    s_waitcnt lgkmcnt(12)
    s_waitcnt lgkmcnt(10)
    v_mfma_f32_32x32x16_bf16 v[64:79], v[156:159], v[128:131], v[64:79]
    ds_read_b64_tr_b16 v[144:145], v230 offset:28672
    ds_read_b64_tr_b16 v[146:147], v230 offset:28928
    s_waitcnt lgkmcnt(10)
    v_mfma_f32_32x32x16_bf16 v[80:95], v[160:163], v[128:131], v[80:95]
    ds_read_b64_tr_b16 v[148:149], v230 offset:29696
    ds_read_b64_tr_b16 v[150:151], v230 offset:29952
    s_waitcnt lgkmcnt(10)
    v_mfma_f32_32x32x16_bf16 v[96:111], v[164:167], v[128:131], v[96:111]
    ds_read_b64_tr_b16 v[152:153], v230 offset:30720
    ds_read_b64_tr_b16 v[154:155], v230 offset:30976
    v_mfma_f32_16x16x32_bf16 v[40:43], v[36:39], v[128:131], v[40:43]
    v_mfma_f32_16x16x32_bf16 v[44:47], v[36:39], v[156:159], v[44:47]
    v_mfma_f32_16x16x32_bf16 v[48:51], v[36:39], v[160:163], v[48:51]
    v_mfma_f32_16x16x32_bf16 v[52:55], v[36:39], v[164:167], v[52:55]
    s_waitcnt lgkmcnt(10)
    v_mfma_f32_32x32x16_bf16 v[64:79], v[168:171], v[132:135], v[64:79]
    ds_read_b64_tr_b16 v[156:157], v231 offset:28672
    ds_read_b64_tr_b16 v[158:159], v231 offset:28928
    s_waitcnt lgkmcnt(10)
    v_mfma_f32_32x32x16_bf16 v[80:95], v[172:175], v[132:135], v[80:95]
    ds_read_b64_tr_b16 v[160:161], v231 offset:29696
    ds_read_b64_tr_b16 v[162:163], v231 offset:29952
    s_waitcnt lgkmcnt(10)
    v_mfma_f32_32x32x16_bf16 v[96:111], v[176:179], v[132:135], v[96:111]
    ds_read_b64_tr_b16 v[164:165], v231 offset:30720
    ds_read_b64_tr_b16 v[166:167], v231 offset:30976
    v_mfma_f32_16x16x32_bf16 v[40:43], v[36:39], v[132:135], v[40:43]
    v_dot2c_f32_bf16 v56, v128, v128
    v_dot2c_f32_bf16 v57, v129, v129
    v_dot2c_f32_bf16 v58, v130, v130
    v_dot2c_f32_bf16 v59, v131, v131
    v_dot2c_f32_bf16 v56, v132, v132
    v_dot2c_f32_bf16 v57, v133, v133
    v_dot2c_f32_bf16 v58, v134, v134
    v_dot2c_f32_bf16 v59, v135, v135
    v_dot2c_f32_bf16 v56, v136, v136
    v_dot2c_f32_bf16 v57, v137, v137
    v_dot2c_f32_bf16 v58, v138, v138
    v_dot2c_f32_bf16 v59, v139, v139
    v_dot2c_f32_bf16 v56, v140, v140
    v_dot2c_f32_bf16 v57, v141, v141
    v_dot2c_f32_bf16 v58, v142, v142
    v_dot2c_f32_bf16 v59, v143, v143
    s_waitcnt lgkmcnt(0)
    s_barrier
    v_mfma_f32_32x32x16_bf16 v[64:79], v[144:147], v[136:139], v[64:79]
    ds_read_b128 v[112:115], v224 offset:0
    ds_read_b128 v[116:119], v225 offset:0
    ds_read_b128 v[120:123], v226 offset:0
    v_mfma_f32_32x32x16_bf16 v[80:95], v[148:151], v[136:139], v[80:95]
    ds_read_b128 v[124:127], v227 offset:0
    ds_read_b64_tr_b16 v[168:169], v232 offset:0
    ds_read_b64_tr_b16 v[170:171], v232 offset:256
    v_mfma_f32_32x32x16_bf16 v[96:111], v[152:155], v[136:139], v[96:111]
    ds_read_b64_tr_b16 v[172:173], v232 offset:1024
    ds_read_b64_tr_b16 v[174:175], v232 offset:1280
    ds_read_b64_tr_b16 v[176:177], v232 offset:2048
    v_mfma_f32_16x16x32_bf16 v[40:43], v[36:39], v[136:139], v[40:43]
    ds_read_b64_tr_b16 v[178:179], v232 offset:2304
    v_mfma_f32_32x32x16_bf16 v[64:79], v[156:159], v[140:143], v[64:79]
    ds_read_b64_tr_b16 v[144:145], v233 offset:0
    ds_read_b64_tr_b16 v[146:147], v233 offset:256
    v_mfma_f32_32x32x16_bf16 v[80:95], v[160:163], v[140:143], v[80:95]
    ds_read_b64_tr_b16 v[148:149], v233 offset:1024
    ds_read_b64_tr_b16 v[150:151], v233 offset:1280
    v_mfma_f32_32x32x16_bf16 v[96:111], v[164:167], v[140:143], v[96:111]
    ds_read_b64_tr_b16 v[152:153], v233 offset:2048
    ds_read_b64_tr_b16 v[154:155], v233 offset:2304
    v_mfma_f32_16x16x32_bf16 v[40:43], v[36:39], v[140:143], v[40:43]
    s_waitcnt lgkmcnt(12)
    s_waitcnt lgkmcnt(10)
    v_mfma_f32_32x32x16_bf16 v[64:79], v[168:171], v[112:115], v[64:79]
    ds_read_b64_tr_b16 v[156:157], v234 offset:0
    ds_read_b64_tr_b16 v[158:159], v234 offset:256
    s_waitcnt lgkmcnt(10)
    v_mfma_f32_32x32x16_bf16 v[80:95], v[172:175], v[112:115], v[80:95]
    ds_read_b64_tr_b16 v[160:161], v234 offset:1024
    ds_read_b64_tr_b16 v[162:163], v234 offset:1280
    s_waitcnt lgkmcnt(10)
    v_mfma_f32_32x32x16_bf16 v[96:111], v[176:179], v[112:115], v[96:111]
    ds_read_b64_tr_b16 v[164:165], v234 offset:2048
    ds_read_b64_tr_b16 v[166:167], v234 offset:2304
    v_mfma_f32_16x16x32_bf16 v[40:43], v[36:39], v[112:115], v[40:43]
    v_mfma_f32_16x16x32_bf16 v[44:47], v[36:39], v[168:171], v[44:47]
    v_mfma_f32_16x16x32_bf16 v[48:51], v[36:39], v[172:175], v[48:51]
    v_mfma_f32_16x16x32_bf16 v[52:55], v[36:39], v[176:179], v[52:55]
    s_waitcnt lgkmcnt(10)
    v_mfma_f32_32x32x16_bf16 v[64:79], v[144:147], v[116:119], v[64:79]
    ds_read_b64_tr_b16 v[168:169], v235 offset:0
    ds_read_b64_tr_b16 v[170:171], v235 offset:256
    s_waitcnt lgkmcnt(10)
    v_mfma_f32_32x32x16_bf16 v[80:95], v[148:151], v[116:119], v[80:95]
    ds_read_b64_tr_b16 v[172:173], v235 offset:1024
    ds_read_b64_tr_b16 v[174:175], v235 offset:1280
    s_waitcnt lgkmcnt(10)
    v_mfma_f32_32x32x16_bf16 v[96:111], v[152:155], v[116:119], v[96:111]
    ds_read_b64_tr_b16 v[176:177], v235 offset:2048
    ds_read_b64_tr_b16 v[178:179], v235 offset:2304
    v_mfma_f32_16x16x32_bf16 v[40:43], v[36:39], v[116:119], v[40:43]
    v_dot2c_f32_bf16 v56, v112, v112
    v_dot2c_f32_bf16 v57, v113, v113
    v_dot2c_f32_bf16 v58, v114, v114
    v_dot2c_f32_bf16 v59, v115, v115
    v_dot2c_f32_bf16 v56, v116, v116
    v_dot2c_f32_bf16 v57, v117, v117
    v_dot2c_f32_bf16 v58, v118, v118
    v_dot2c_f32_bf16 v59, v119, v119
    v_dot2c_f32_bf16 v56, v120, v120
    v_dot2c_f32_bf16 v57, v121, v121
    v_dot2c_f32_bf16 v58, v122, v122
    v_dot2c_f32_bf16 v59, v123, v123
    v_dot2c_f32_bf16 v56, v124, v124
    v_dot2c_f32_bf16 v57, v125, v125
    v_dot2c_f32_bf16 v58, v126, v126
    v_dot2c_f32_bf16 v59, v127, v127
    s_waitcnt lgkmcnt(0)
    s_barrier
    v_mfma_f32_32x32x16_bf16 v[64:79], v[156:159], v[120:123], v[64:79]
    ds_read_b128 v[128:131], v224 offset:28672
    ds_read_b128 v[132:135], v225 offset:28672
    ds_read_b128 v[136:139], v226 offset:28672
    v_mfma_f32_32x32x16_bf16 v[80:95], v[160:163], v[120:123], v[80:95]
    ds_read_b128 v[140:143], v227 offset:28672
    ds_read_b64_tr_b16 v[144:145], v232 offset:28672
    ds_read_b64_tr_b16 v[146:147], v232 offset:28928
    v_mfma_f32_32x32x16_bf16 v[96:111], v[164:167], v[120:123], v[96:111]
    ds_read_b64_tr_b16 v[148:149], v232 offset:29696
    ds_read_b64_tr_b16 v[150:151], v232 offset:29952
    ds_read_b64_tr_b16 v[152:153], v232 offset:30720
    v_mfma_f32_16x16x32_bf16 v[40:43], v[36:39], v[120:123], v[40:43]
    ds_read_b64_tr_b16 v[154:155], v232 offset:30976
    v_mfma_f32_32x32x16_bf16 v[64:79], v[168:171], v[124:127], v[64:79]
    ds_read_b64_tr_b16 v[156:157], v233 offset:28672
    ds_read_b64_tr_b16 v[158:159], v233 offset:28928
    v_mfma_f32_32x32x16_bf16 v[80:95], v[172:175], v[124:127], v[80:95]
    ds_read_b64_tr_b16 v[160:161], v233 offset:29696
    ds_read_b64_tr_b16 v[162:163], v233 offset:29952
    v_mfma_f32_32x32x16_bf16 v[96:111], v[176:179], v[124:127], v[96:111]
    ds_read_b64_tr_b16 v[164:165], v233 offset:30720
    ds_read_b64_tr_b16 v[166:167], v233 offset:30976
    v_mfma_f32_16x16x32_bf16 v[40:43], v[36:39], v[124:127], v[40:43]
    s_waitcnt lgkmcnt(12)
    s_waitcnt lgkmcnt(10)
    v_mfma_f32_32x32x16_bf16 v[64:79], v[144:147], v[128:131], v[64:79]
    ds_read_b64_tr_b16 v[168:169], v234 offset:28672
    ds_read_b64_tr_b16 v[170:171], v234 offset:28928
    s_waitcnt lgkmcnt(10)
    v_mfma_f32_32x32x16_bf16 v[80:95], v[148:151], v[128:131], v[80:95]
    ds_read_b64_tr_b16 v[172:173], v234 offset:29696
    ds_read_b64_tr_b16 v[174:175], v234 offset:29952
    s_waitcnt lgkmcnt(10)
    v_mfma_f32_32x32x16_bf16 v[96:111], v[152:155], v[128:131], v[96:111]
    ds_read_b64_tr_b16 v[176:177], v234 offset:30720
    ds_read_b64_tr_b16 v[178:179], v234 offset:30976
    v_mfma_f32_16x16x32_bf16 v[40:43], v[36:39], v[128:131], v[40:43]
    v_mfma_f32_16x16x32_bf16 v[44:47], v[36:39], v[144:147], v[44:47]
    v_mfma_f32_16x16x32_bf16 v[48:51], v[36:39], v[148:151], v[48:51]
    v_mfma_f32_16x16x32_bf16 v[52:55], v[36:39], v[152:155], v[52:55]
    s_waitcnt lgkmcnt(10)
    v_mfma_f32_32x32x16_bf16 v[64:79], v[156:159], v[132:135], v[64:79]
    ds_read_b64_tr_b16 v[144:145], v235 offset:28672
    ds_read_b64_tr_b16 v[146:147], v235 offset:28928
    s_waitcnt lgkmcnt(10)
    v_mfma_f32_32x32x16_bf16 v[80:95], v[160:163], v[132:135], v[80:95]
    ds_read_b64_tr_b16 v[148:149], v235 offset:29696
    ds_read_b64_tr_b16 v[150:151], v235 offset:29952
    s_waitcnt lgkmcnt(10)
    v_mfma_f32_32x32x16_bf16 v[96:111], v[164:167], v[132:135], v[96:111]
    ds_read_b64_tr_b16 v[152:153], v235 offset:30720
    ds_read_b64_tr_b16 v[154:155], v235 offset:30976
    v_mfma_f32_16x16x32_bf16 v[40:43], v[36:39], v[132:135], v[40:43]
    v_dot2c_f32_bf16 v56, v128, v128
    v_dot2c_f32_bf16 v57, v129, v129
    v_dot2c_f32_bf16 v58, v130, v130
    v_dot2c_f32_bf16 v59, v131, v131
    v_dot2c_f32_bf16 v56, v132, v132
    v_dot2c_f32_bf16 v57, v133, v133
    v_dot2c_f32_bf16 v58, v134, v134
    v_dot2c_f32_bf16 v59, v135, v135
    v_dot2c_f32_bf16 v56, v136, v136
    v_dot2c_f32_bf16 v57, v137, v137
    v_dot2c_f32_bf16 v58, v138, v138
    v_dot2c_f32_bf16 v59, v139, v139
    v_dot2c_f32_bf16 v56, v140, v140
    v_dot2c_f32_bf16 v57, v141, v141
    v_dot2c_f32_bf16 v58, v142, v142
    v_dot2c_f32_bf16 v59, v143, v143
    s_waitcnt lgkmcnt(0)
    s_barrier
    v_mfma_f32_32x32x16_bf16 v[64:79], v[168:171], v[136:139], v[64:79]
    ds_read_b128 v[112:115], v220 offset:0
    ds_read_b128 v[116:119], v221 offset:0
    ds_read_b128 v[120:123], v222 offset:0
    v_mfma_f32_32x32x16_bf16 v[80:95], v[172:175], v[136:139], v[80:95]
    ds_read_b128 v[124:127], v223 offset:0
    ds_read_b64_tr_b16 v[156:157], v228 offset:0
    ds_read_b64_tr_b16 v[158:159], v228 offset:256
    v_mfma_f32_32x32x16_bf16 v[96:111], v[176:179], v[136:139], v[96:111]
    ds_read_b64_tr_b16 v[160:161], v228 offset:1024
    ds_read_b64_tr_b16 v[162:163], v228 offset:1280
    ds_read_b64_tr_b16 v[164:165], v228 offset:2048
    v_mfma_f32_16x16x32_bf16 v[40:43], v[36:39], v[136:139], v[40:43]
    ds_read_b64_tr_b16 v[166:167], v228 offset:2304
    v_mfma_f32_32x32x16_bf16 v[64:79], v[144:147], v[140:143], v[64:79]
    ds_read_b64_tr_b16 v[168:169], v229 offset:0
    ds_read_b64_tr_b16 v[170:171], v229 offset:256
    v_mfma_f32_32x32x16_bf16 v[80:95], v[148:151], v[140:143], v[80:95]
    ds_read_b64_tr_b16 v[172:173], v229 offset:1024
    ds_read_b64_tr_b16 v[174:175], v229 offset:1280
    v_mfma_f32_32x32x16_bf16 v[96:111], v[152:155], v[140:143], v[96:111]
    ds_read_b64_tr_b16 v[176:177], v229 offset:2048
    ds_read_b64_tr_b16 v[178:179], v229 offset:2304
    v_mfma_f32_16x16x32_bf16 v[40:43], v[36:39], v[140:143], v[40:43]
    s_waitcnt lgkmcnt(12)
    s_waitcnt lgkmcnt(10)
    v_mfma_f32_32x32x16_bf16 v[64:79], v[156:159], v[112:115], v[64:79]
    ds_read_b64_tr_b16 v[144:145], v230 offset:0
    ds_read_b64_tr_b16 v[146:147], v230 offset:256
    s_waitcnt lgkmcnt(10)
    v_mfma_f32_32x32x16_bf16 v[80:95], v[160:163], v[112:115], v[80:95]
    ds_read_b64_tr_b16 v[148:149], v230 offset:1024
    ds_read_b64_tr_b16 v[150:151], v230 offset:1280
    s_waitcnt lgkmcnt(10)
    v_mfma_f32_32x32x16_bf16 v[96:111], v[164:167], v[112:115], v[96:111]
    ds_read_b64_tr_b16 v[152:153], v230 offset:2048
    ds_read_b64_tr_b16 v[154:155], v230 offset:2304
    v_mfma_f32_16x16x32_bf16 v[40:43], v[36:39], v[112:115], v[40:43]
    v_mfma_f32_16x16x32_bf16 v[44:47], v[36:39], v[156:159], v[44:47]
    v_mfma_f32_16x16x32_bf16 v[48:51], v[36:39], v[160:163], v[48:51]
    v_mfma_f32_16x16x32_bf16 v[52:55], v[36:39], v[164:167], v[52:55]
    s_waitcnt lgkmcnt(10)
    v_mfma_f32_32x32x16_bf16 v[64:79], v[168:171], v[116:119], v[64:79]
    ds_read_b64_tr_b16 v[156:157], v231 offset:0
    ds_read_b64_tr_b16 v[158:159], v231 offset:256
    s_waitcnt lgkmcnt(10)
    v_mfma_f32_32x32x16_bf16 v[80:95], v[172:175], v[116:119], v[80:95]
    ds_read_b64_tr_b16 v[160:161], v231 offset:1024
    ds_read_b64_tr_b16 v[162:163], v231 offset:1280
    s_waitcnt lgkmcnt(10)
    v_mfma_f32_32x32x16_bf16 v[96:111], v[176:179], v[116:119], v[96:111]
    ds_read_b64_tr_b16 v[164:165], v231 offset:2048
    ds_read_b64_tr_b16 v[166:167], v231 offset:2304
    v_mfma_f32_16x16x32_bf16 v[40:43], v[36:39], v[116:119], v[40:43]
    v_dot2c_f32_bf16 v56, v112, v112
    v_dot2c_f32_bf16 v57, v113, v113
    v_dot2c_f32_bf16 v58, v114, v114
    v_dot2c_f32_bf16 v59, v115, v115
    v_dot2c_f32_bf16 v56, v116, v116
    v_dot2c_f32_bf16 v57, v117, v117
    v_dot2c_f32_bf16 v58, v118, v118
    v_dot2c_f32_bf16 v59, v119, v119
    v_dot2c_f32_bf16 v56, v120, v120
    v_dot2c_f32_bf16 v57, v121, v121
    v_dot2c_f32_bf16 v58, v122, v122
    v_dot2c_f32_bf16 v59, v123, v123
    v_dot2c_f32_bf16 v56, v124, v124
    v_dot2c_f32_bf16 v57, v125, v125
    v_dot2c_f32_bf16 v58, v126, v126
    v_dot2c_f32_bf16 v59, v127, v127
    s_waitcnt lgkmcnt(0)
    s_barrier
    v_mfma_f32_32x32x16_bf16 v[64:79], v[144:147], v[120:123], v[64:79]
    ds_read_b128 v[128:131], v220 offset:28672
    ds_read_b128 v[132:135], v221 offset:28672
    ds_read_b128 v[136:139], v222 offset:28672
    v_mfma_f32_32x32x16_bf16 v[80:95], v[148:151], v[120:123], v[80:95]
    ds_read_b128 v[140:143], v223 offset:28672
    ds_read_b64_tr_b16 v[168:169], v228 offset:28672
    ds_read_b64_tr_b16 v[170:171], v228 offset:28928
    v_mfma_f32_32x32x16_bf16 v[96:111], v[152:155], v[120:123], v[96:111]
    ds_read_b64_tr_b16 v[172:173], v228 offset:29696
    ds_read_b64_tr_b16 v[174:175], v228 offset:29952
    ds_read_b64_tr_b16 v[176:177], v228 offset:30720
    v_mfma_f32_16x16x32_bf16 v[40:43], v[36:39], v[120:123], v[40:43]
    ds_read_b64_tr_b16 v[178:179], v228 offset:30976
    v_mfma_f32_32x32x16_bf16 v[64:79], v[156:159], v[124:127], v[64:79]
    ds_read_b64_tr_b16 v[144:145], v229 offset:28672
    ds_read_b64_tr_b16 v[146:147], v229 offset:28928
    v_mfma_f32_32x32x16_bf16 v[80:95], v[160:163], v[124:127], v[80:95]
    ds_read_b64_tr_b16 v[148:149], v229 offset:29696
    ds_read_b64_tr_b16 v[150:151], v229 offset:29952
    v_mfma_f32_32x32x16_bf16 v[96:111], v[164:167], v[124:127], v[96:111]
    ds_read_b64_tr_b16 v[152:153], v229 offset:30720
    ds_read_b64_tr_b16 v[154:155], v229 offset:30976
    v_mfma_f32_16x16x32_bf16 v[40:43], v[36:39], v[124:127], v[40:43]
    s_waitcnt lgkmcnt(12)
    s_waitcnt lgkmcnt(10)
    v_mfma_f32_32x32x16_bf16 v[64:79], v[168:171], v[128:131], v[64:79]
    ds_read_b64_tr_b16 v[156:157], v230 offset:28672
    ds_read_b64_tr_b16 v[158:159], v230 offset:28928
    s_waitcnt lgkmcnt(10)
    v_mfma_f32_32x32x16_bf16 v[80:95], v[172:175], v[128:131], v[80:95]
    ds_read_b64_tr_b16 v[160:161], v230 offset:29696
    ds_read_b64_tr_b16 v[162:163], v230 offset:29952
    s_waitcnt lgkmcnt(10)
    v_mfma_f32_32x32x16_bf16 v[96:111], v[176:179], v[128:131], v[96:111]
    ds_read_b64_tr_b16 v[164:165], v230 offset:30720
    ds_read_b64_tr_b16 v[166:167], v230 offset:30976
    v_mfma_f32_16x16x32_bf16 v[40:43], v[36:39], v[128:131], v[40:43]
    v_mfma_f32_16x16x32_bf16 v[44:47], v[36:39], v[168:171], v[44:47]
    v_mfma_f32_16x16x32_bf16 v[48:51], v[36:39], v[172:175], v[48:51]
    v_mfma_f32_16x16x32_bf16 v[52:55], v[36:39], v[176:179], v[52:55]
    s_waitcnt lgkmcnt(10)
    v_mfma_f32_32x32x16_bf16 v[64:79], v[144:147], v[132:135], v[64:79]
    ds_read_b64_tr_b16 v[168:169], v231 offset:28672
    ds_read_b64_tr_b16 v[170:171], v231 offset:28928
    s_waitcnt lgkmcnt(10)
    v_mfma_f32_32x32x16_bf16 v[80:95], v[148:151], v[132:135], v[80:95]
    ds_read_b64_tr_b16 v[172:173], v231 offset:29696
    ds_read_b64_tr_b16 v[174:175], v231 offset:29952
    s_waitcnt lgkmcnt(10)
    v_mfma_f32_32x32x16_bf16 v[96:111], v[152:155], v[132:135], v[96:111]
    ds_read_b64_tr_b16 v[176:177], v231 offset:30720
    ds_read_b64_tr_b16 v[178:179], v231 offset:30976
    v_mfma_f32_16x16x32_bf16 v[40:43], v[36:39], v[132:135], v[40:43]
    v_dot2c_f32_bf16 v56, v128, v128
    v_dot2c_f32_bf16 v57, v129, v129
    v_dot2c_f32_bf16 v58, v130, v130
    v_dot2c_f32_bf16 v59, v131, v131
    v_dot2c_f32_bf16 v56, v132, v132
    v_dot2c_f32_bf16 v57, v133, v133
    v_dot2c_f32_bf16 v58, v134, v134
    v_dot2c_f32_bf16 v59, v135, v135
    v_dot2c_f32_bf16 v56, v136, v136
    v_dot2c_f32_bf16 v57, v137, v137
    v_dot2c_f32_bf16 v58, v138, v138
    v_dot2c_f32_bf16 v59, v139, v139
    v_dot2c_f32_bf16 v56, v140, v140
    v_dot2c_f32_bf16 v57, v141, v141
    v_dot2c_f32_bf16 v58, v142, v142
    v_dot2c_f32_bf16 v59, v143, v143
    s_waitcnt lgkmcnt(0)
    s_barrier
    v_mfma_f32_32x32x16_bf16 v[64:79], v[156:159], v[136:139], v[64:79]
    ds_read_b128 v[112:115], v224 offset:0
    ds_read_b128 v[116:119], v225 offset:0
    ds_read_b128 v[120:123], v226 offset:0
    v_mfma_f32_32x32x16_bf16 v[80:95], v[160:163], v[136:139], v[80:95]
    ds_read_b128 v[124:127], v227 offset:0
    ds_read_b64_tr_b16 v[144:145], v232 offset:0
    ds_read_b64_tr_b16 v[146:147], v232 offset:256
    v_mfma_f32_32x32x16_bf16 v[96:111], v[164:167], v[136:139], v[96:111]
    ds_read_b64_tr_b16 v[148:149], v232 offset:1024
    ds_read_b64_tr_b16 v[150:151], v232 offset:1280
    ds_read_b64_tr_b16 v[152:153], v232 offset:2048
    v_mfma_f32_16x16x32_bf16 v[40:43], v[36:39], v[136:139], v[40:43]
    ds_read_b64_tr_b16 v[154:155], v232 offset:2304
    v_mfma_f32_32x32x16_bf16 v[64:79], v[168:171], v[140:143], v[64:79]
    ds_read_b64_tr_b16 v[156:157], v233 offset:0
    ds_read_b64_tr_b16 v[158:159], v233 offset:256
    v_mfma_f32_32x32x16_bf16 v[80:95], v[172:175], v[140:143], v[80:95]
    ds_read_b64_tr_b16 v[160:161], v233 offset:1024
    ds_read_b64_tr_b16 v[162:163], v233 offset:1280
    v_mfma_f32_32x32x16_bf16 v[96:111], v[176:179], v[140:143], v[96:111]
    ds_read_b64_tr_b16 v[164:165], v233 offset:2048
    ds_read_b64_tr_b16 v[166:167], v233 offset:2304
    v_mfma_f32_16x16x32_bf16 v[40:43], v[36:39], v[140:143], v[40:43]
    s_waitcnt lgkmcnt(12)
    s_waitcnt lgkmcnt(10)
    v_mfma_f32_32x32x16_bf16 v[64:79], v[144:147], v[112:115], v[64:79]
    ds_read_b64_tr_b16 v[168:169], v234 offset:0
    ds_read_b64_tr_b16 v[170:171], v234 offset:256
    s_waitcnt lgkmcnt(10)
    v_mfma_f32_32x32x16_bf16 v[80:95], v[148:151], v[112:115], v[80:95]
    ds_read_b64_tr_b16 v[172:173], v234 offset:1024
    ds_read_b64_tr_b16 v[174:175], v234 offset:1280
    s_waitcnt lgkmcnt(10)
    v_mfma_f32_32x32x16_bf16 v[96:111], v[152:155], v[112:115], v[96:111]
    ds_read_b64_tr_b16 v[176:177], v234 offset:2048
    ds_read_b64_tr_b16 v[178:179], v234 offset:2304
    v_mfma_f32_16x16x32_bf16 v[40:43], v[36:39], v[112:115], v[40:43]
    v_mfma_f32_16x16x32_bf16 v[44:47], v[36:39], v[144:147], v[44:47]
    v_mfma_f32_16x16x32_bf16 v[48:51], v[36:39], v[148:151], v[48:51]
    v_mfma_f32_16x16x32_bf16 v[52:55], v[36:39], v[152:155], v[52:55]
    s_waitcnt lgkmcnt(10)
    v_mfma_f32_32x32x16_bf16 v[64:79], v[156:159], v[116:119], v[64:79]
    ds_read_b64_tr_b16 v[144:145], v235 offset:0
    ds_read_b64_tr_b16 v[146:147], v235 offset:256
    s_waitcnt lgkmcnt(10)
    v_mfma_f32_32x32x16_bf16 v[80:95], v[160:163], v[116:119], v[80:95]
    ds_read_b64_tr_b16 v[148:149], v235 offset:1024
    ds_read_b64_tr_b16 v[150:151], v235 offset:1280
    s_waitcnt lgkmcnt(10)
    v_mfma_f32_32x32x16_bf16 v[96:111], v[164:167], v[116:119], v[96:111]
    ds_read_b64_tr_b16 v[152:153], v235 offset:2048
    ds_read_b64_tr_b16 v[154:155], v235 offset:2304
    v_mfma_f32_16x16x32_bf16 v[40:43], v[36:39], v[116:119], v[40:43]
    v_dot2c_f32_bf16 v56, v112, v112
    v_dot2c_f32_bf16 v57, v113, v113
    v_dot2c_f32_bf16 v58, v114, v114
    v_dot2c_f32_bf16 v59, v115, v115
    v_dot2c_f32_bf16 v56, v116, v116
    v_dot2c_f32_bf16 v57, v117, v117
    v_dot2c_f32_bf16 v58, v118, v118
    v_dot2c_f32_bf16 v59, v119, v119
    v_dot2c_f32_bf16 v56, v120, v120
    v_dot2c_f32_bf16 v57, v121, v121
    v_dot2c_f32_bf16 v58, v122, v122
    v_dot2c_f32_bf16 v59, v123, v123
    v_dot2c_f32_bf16 v56, v124, v124
    v_dot2c_f32_bf16 v57, v125, v125
    v_dot2c_f32_bf16 v58, v126, v126
    v_dot2c_f32_bf16 v59, v127, v127
    s_waitcnt lgkmcnt(0)
    s_barrier
    v_mfma_f32_32x32x16_bf16 v[64:79], v[168:171], v[120:123], v[64:79]
    ds_read_b128 v[128:131], v224 offset:28672
    ds_read_b128 v[132:135], v225 offset:28672
    ds_read_b128 v[136:139], v226 offset:28672
    v_mfma_f32_32x32x16_bf16 v[80:95], v[172:175], v[120:123], v[80:95]
    ds_read_b128 v[140:143], v227 offset:28672
    ds_read_b64_tr_b16 v[156:157], v232 offset:28672
    ds_read_b64_tr_b16 v[158:159], v232 offset:28928
    v_mfma_f32_32x32x16_bf16 v[96:111], v[176:179], v[120:123], v[96:111]
    ds_read_b64_tr_b16 v[160:161], v232 offset:29696
    ds_read_b64_tr_b16 v[162:163], v232 offset:29952
    ds_read_b64_tr_b16 v[164:165], v232 offset:30720
    v_mfma_f32_16x16x32_bf16 v[40:43], v[36:39], v[120:123], v[40:43]
    ds_read_b64_tr_b16 v[166:167], v232 offset:30976
    v_mfma_f32_32x32x16_bf16 v[64:79], v[144:147], v[124:127], v[64:79]
    ds_read_b64_tr_b16 v[168:169], v233 offset:28672
    ds_read_b64_tr_b16 v[170:171], v233 offset:28928
    v_mfma_f32_32x32x16_bf16 v[80:95], v[148:151], v[124:127], v[80:95]
    ds_read_b64_tr_b16 v[172:173], v233 offset:29696
    ds_read_b64_tr_b16 v[174:175], v233 offset:29952
    v_mfma_f32_32x32x16_bf16 v[96:111], v[152:155], v[124:127], v[96:111]
    ds_read_b64_tr_b16 v[176:177], v233 offset:30720
    ds_read_b64_tr_b16 v[178:179], v233 offset:30976
    v_mfma_f32_16x16x32_bf16 v[40:43], v[36:39], v[124:127], v[40:43]
    s_waitcnt lgkmcnt(12)
    s_waitcnt lgkmcnt(6)
    v_mfma_f32_16x16x32_bf16 v[44:47], v[36:39], v[156:159], v[44:47]
    ds_read_b64_tr_b16 v[144:145], v234 offset:28672
    v_mfma_f32_16x16x32_bf16 v[48:51], v[36:39], v[160:163], v[48:51]
    ds_read_b64_tr_b16 v[146:147], v234 offset:28928
    v_mfma_f32_16x16x32_bf16 v[52:55], v[36:39], v[164:167], v[52:55]
    ds_read_b64_tr_b16 v[148:149], v234 offset:29696
    v_mfma_f32_16x16x32_bf16 v[40:43], v[36:39], v[128:131], v[40:43]
    ds_read_b64_tr_b16 v[150:151], v234 offset:29952
    v_mfma_f32_16x16x32_bf16 v[40:43], v[36:39], v[132:135], v[40:43]
    ds_read_b64_tr_b16 v[152:153], v234 offset:30720
    v_mfma_f32_16x16x32_bf16 v[40:43], v[36:39], v[136:139], v[40:43]
    ds_read_b64_tr_b16 v[154:155], v234 offset:30976
    v_mfma_f32_16x16x32_bf16 v[40:43], v[36:39], v[140:143], v[40:43]
    v_dot2c_f32_bf16 v56, v128, v128
    v_dot2c_f32_bf16 v57, v129, v129
    v_dot2c_f32_bf16 v58, v130, v130
    v_dot2c_f32_bf16 v59, v131, v131
    v_dot2c_f32_bf16 v56, v132, v132
    v_dot2c_f32_bf16 v57, v133, v133
    v_dot2c_f32_bf16 v58, v134, v134
    v_dot2c_f32_bf16 v59, v135, v135
    v_dot2c_f32_bf16 v56, v136, v136
    v_dot2c_f32_bf16 v57, v137, v137
    v_dot2c_f32_bf16 v58, v138, v138
    v_dot2c_f32_bf16 v59, v139, v139
    v_dot2c_f32_bf16 v56, v140, v140
    v_dot2c_f32_bf16 v57, v141, v141
    v_dot2c_f32_bf16 v58, v142, v142
    v_dot2c_f32_bf16 v59, v143, v143
    v_mfma_f32_32x32x16_bf16 v[64:79], v[156:159], v[128:131], v[64:79]
    v_cndmask_b32 v23, v44, v45, vcc
    v_cvt_pk_bf16_f32 v24, v23, v23
    v_lshlrev_b32 v24, 16, v24
    v_sub_f32 v23, v23, v24
    v_cvt_pk_bf16_f32 v46, v24, v23
    v_mfma_f32_32x32x16_bf16 v[80:95], v[160:163], v[128:131], v[80:95]
    ds_write_b32 v26, v46 offset:0
    v_cndmask_b32 v23, v48, v49, vcc
    v_cvt_pk_bf16_f32 v24, v23, v23
    v_lshlrev_b32 v24, 16, v24
    v_sub_f32 v23, v23, v24
    v_mfma_f32_32x32x16_bf16 v[96:111], v[164:167], v[128:131], v[96:111]
    v_cvt_pk_bf16_f32 v50, v24, v23
    ds_write_b32 v26, v50 offset:512
    v_cndmask_b32 v23, v52, v53, vcc
    v_cvt_pk_bf16_f32 v24, v23, v23
    v_lshlrev_b32 v24, 16, v24
    s_waitcnt lgkmcnt(12)
    v_mfma_f32_32x32x16_bf16 v[64:79], v[168:171], v[132:135], v[64:79]
    ds_read_b64_tr_b16 v[156:157], v235 offset:28672
    ds_read_b64_tr_b16 v[158:159], v235 offset:28928
    v_sub_f32 v23, v23, v24
    s_waitcnt lgkmcnt(12)
    v_mfma_f32_32x32x16_bf16 v[80:95], v[172:175], v[132:135], v[80:95]
    ds_read_b64_tr_b16 v[160:161], v235 offset:29696
    ds_read_b64_tr_b16 v[162:163], v235 offset:29952
    v_cvt_pk_bf16_f32 v54, v24, v23
    s_waitcnt lgkmcnt(12)
    v_mfma_f32_32x32x16_bf16 v[96:111], v[176:179], v[132:135], v[96:111]
    ds_read_b64_tr_b16 v[164:165], v235 offset:30720
    ds_read_b64_tr_b16 v[166:167], v235 offset:30976
    ds_write_b32 v26, v54 offset:1024
    ds_write_b32 v6, v8 offset:0
    s_waitcnt lgkmcnt(14)
    v_mfma_f32_32x32x16_bf16 v[64:79], v[144:147], v[136:139], v[64:79]
    v_cndmask_b32 v20, v40, v41, vcc
    v_add_f32 v56, v56, v57
    v_add_f32 v58, v58, v59
    v_mul_f32 v20, 0x3b000000, v20
    v_add_f32 v56, v56, v58
    s_waitcnt lgkmcnt(12)
    v_mfma_f32_32x32x16_bf16 v[80:95], v[148:151], v[136:139], v[80:95]
    v_mov_b32 v57, v56
    v_cmp_gt_u32 s[6:7], 32, v1
    s_nop 0
    v_permlane32_swap_b32 v56, v57
    v_add_f32 v56, v56, v57
    v_mul_f32 v56, 0x3b000000, v56
    s_waitcnt lgkmcnt(10)
    v_mfma_f32_32x32x16_bf16 v[96:111], v[152:155], v[136:139], v[96:111]
    v_fma_f32 v56, -v20, v20, v56
    v_max_f32 v56, 0, v56
    v_cvt_pk_bf16_f32 v23, v20, v56
    v_lshlrev_b32 v20, 16, v23
    v_and_b32 v24, 0xffff0000, v23
    ds_read_b32 v9, v7 offset:0
    s_waitcnt lgkmcnt(7)
    v_mfma_f32_32x32x16_bf16 v[64:79], v[156:159], v[140:143], v[64:79]
    v_cvt_pk_bf16_f32 v23, -v20, -v20
    v_add_f32 v24, 0x3727c5ac, v24
    v_cvt_pk_bf16_f32 v24, v24, v24
    v_cndmask_b32 v40, 0, v23, s[6:7]
    v_mov_b32 v41, v40
    s_waitcnt lgkmcnt(5)
    v_mfma_f32_32x32x16_bf16 v[80:95], v[160:163], v[140:143], v[80:95]
    v_mov_b32 v42, v40
    v_mov_b32 v43, v40
    v_lshlrev_b32 v24, 16, v24
    v_sqrt_f32 v24, v24
    s_waitcnt lgkmcnt(3)
    v_mfma_f32_32x32x16_bf16 v[96:111], v[164:167], v[140:143], v[96:111]
    v_cvt_pk_bf16_f32 v24, v24, v24
    v_lshlrev_b32 v32, 16, v24
    v_mov_b32 v33, v32
    v_rcp_f32 v21, v32
    s_nop 0
    v_mul_f32 v30, 0xbfb8aa3b, v21
    s_waitcnt lgkmcnt(0)
    v_cmp_ne_u32 vcc, 1, v9
    s_nop 1
    s_cbranch_vccnz LSLC4
LOKC2:
    ds_read_b128 v[44:47], v27 offset:0
    ds_read_b128 v[48:51], v27 offset:512
    ds_read_b128 v[52:55], v27 offset:1024
    s_waitcnt lgkmcnt(2)
    v_mfma_f32_32x32x16_bf16 v[64:79], v[44:47], v[40:43], v[64:79]
    v_mov_b32 v31, v30
    ds_write_b64 v28, v[20:21]
    s_waitcnt lgkmcnt(2)
    v_mfma_f32_32x32x16_bf16 v[80:95], v[48:51], v[40:43], v[80:95]
    s_waitcnt lgkmcnt(1)
    v_mfma_f32_32x32x16_bf16 v[96:111], v[52:55], v[40:43], v[96:111]
    s_waitcnt vmcnt(0)
    s_nop 4
    v_pk_mul_f32 v[180:181], v[64:65], v[30:31]
    v_pk_mul_f32 v[182:183], v[66:67], v[30:31]
    v_pk_mul_f32 v[184:185], v[68:69], v[30:31]
    v_pk_mul_f32 v[186:187], v[70:71], v[30:31]
    v_pk_mul_f32 v[188:189], v[72:73], v[30:31]
    v_pk_mul_f32 v[190:191], v[74:75], v[30:31]
    v_pk_mul_f32 v[192:193], v[76:77], v[30:31]
    v_pk_mul_f32 v[194:195], v[78:79], v[30:31]
    v_exp_f32 v180, v180
    v_exp_f32 v181, v181
    v_exp_f32 v182, v182
    v_exp_f32 v183, v183
    v_exp_f32 v184, v184
    v_exp_f32 v185, v185
    v_exp_f32 v186, v186
    v_exp_f32 v187, v187
    v_exp_f32 v188, v188
    v_exp_f32 v189, v189
    v_exp_f32 v190, v190
    v_exp_f32 v191, v191
    v_exp_f32 v192, v192
    v_exp_f32 v193, v193
    v_exp_f32 v194, v194
    v_exp_f32 v195, v195
    v_pk_fma_f32 v[180:181], v[180:181], v[32:33], v[32:33]
    v_pk_fma_f32 v[182:183], v[182:183], v[32:33], v[32:33]
    v_pk_fma_f32 v[184:185], v[184:185], v[32:33], v[32:33]
    v_pk_fma_f32 v[186:187], v[186:187], v[32:33], v[32:33]
    v_pk_fma_f32 v[188:189], v[188:189], v[32:33], v[32:33]
    v_pk_fma_f32 v[190:191], v[190:191], v[32:33], v[32:33]
    v_pk_fma_f32 v[192:193], v[192:193], v[32:33], v[32:33]
    v_pk_fma_f32 v[194:195], v[194:195], v[32:33], v[32:33]
    v_rcp_f32 v180, v180
    v_rcp_f32 v181, v181
    v_rcp_f32 v182, v182
    v_rcp_f32 v183, v183
    v_rcp_f32 v184, v184
    v_rcp_f32 v185, v185
    v_rcp_f32 v186, v186
    v_rcp_f32 v187, v187
    v_rcp_f32 v188, v188
    v_rcp_f32 v189, v189
    v_rcp_f32 v190, v190
    v_rcp_f32 v191, v191
    v_rcp_f32 v192, v192
    v_rcp_f32 v193, v193
    v_rcp_f32 v194, v194
    v_rcp_f32 v195, v195
    v_pk_mul_f32 v[180:181], v[180:181], v[64:65]
    v_pk_mul_f32 v[182:183], v[182:183], v[66:67]
    v_pk_mul_f32 v[184:185], v[184:185], v[68:69]
    v_pk_mul_f32 v[186:187], v[186:187], v[70:71]
    v_pk_mul_f32 v[188:189], v[188:189], v[72:73]
    v_pk_mul_f32 v[190:191], v[190:191], v[74:75]
    v_pk_mul_f32 v[192:193], v[192:193], v[76:77]
    v_pk_mul_f32 v[194:195], v[194:195], v[78:79]
    v_cvt_pk_bf16_f32 v196, v180, v181
    v_cvt_pk_bf16_f32 v197, v182, v183
    v_cvt_pk_bf16_f32 v198, v184, v185
    v_cvt_pk_bf16_f32 v199, v186, v187
    buffer_store_dwordx4 v[196:199], v2, s[56:59], s92 offen offset:0 sc1
    v_cvt_pk_bf16_f32 v200, v188, v189
    v_cvt_pk_bf16_f32 v201, v190, v191
    v_cvt_pk_bf16_f32 v202, v192, v193
    v_cvt_pk_bf16_f32 v203, v194, v195
    buffer_store_dwordx4 v[200:203], v2, s[56:59], s92 offen offset:1024 sc1
    v_pk_mul_f32 v[180:181], v[80:81], v[30:31]
    v_pk_mul_f32 v[182:183], v[82:83], v[30:31]
    v_pk_mul_f32 v[184:185], v[84:85], v[30:31]
    v_pk_mul_f32 v[186:187], v[86:87], v[30:31]
    v_pk_mul_f32 v[188:189], v[88:89], v[30:31]
    v_pk_mul_f32 v[190:191], v[90:91], v[30:31]
    v_pk_mul_f32 v[192:193], v[92:93], v[30:31]
    v_pk_mul_f32 v[194:195], v[94:95], v[30:31]
    v_exp_f32 v180, v180
    v_exp_f32 v181, v181
    v_exp_f32 v182, v182
    v_exp_f32 v183, v183
    v_exp_f32 v184, v184
    v_exp_f32 v185, v185
    v_exp_f32 v186, v186
    v_exp_f32 v187, v187
    v_exp_f32 v188, v188
    v_exp_f32 v189, v189
    v_exp_f32 v190, v190
    v_exp_f32 v191, v191
    v_exp_f32 v192, v192
    v_exp_f32 v193, v193
    v_exp_f32 v194, v194
    v_exp_f32 v195, v195
    v_pk_fma_f32 v[180:181], v[180:181], v[32:33], v[32:33]
    v_pk_fma_f32 v[182:183], v[182:183], v[32:33], v[32:33]
    v_pk_fma_f32 v[184:185], v[184:185], v[32:33], v[32:33]
    v_pk_fma_f32 v[186:187], v[186:187], v[32:33], v[32:33]
    v_pk_fma_f32 v[188:189], v[188:189], v[32:33], v[32:33]
    v_pk_fma_f32 v[190:191], v[190:191], v[32:33], v[32:33]
    v_pk_fma_f32 v[192:193], v[192:193], v[32:33], v[32:33]
    v_pk_fma_f32 v[194:195], v[194:195], v[32:33], v[32:33]
    v_rcp_f32 v180, v180
    v_rcp_f32 v181, v181
    v_rcp_f32 v182, v182
    v_rcp_f32 v183, v183
    v_rcp_f32 v184, v184
    v_rcp_f32 v185, v185
    v_rcp_f32 v186, v186
    v_rcp_f32 v187, v187
    v_rcp_f32 v188, v188
    v_rcp_f32 v189, v189
    v_rcp_f32 v190, v190
    v_rcp_f32 v191, v191
    v_rcp_f32 v192, v192
    v_rcp_f32 v193, v193
    v_rcp_f32 v194, v194
    v_rcp_f32 v195, v195
    v_pk_mul_f32 v[180:181], v[180:181], v[80:81]
    v_pk_mul_f32 v[182:183], v[182:183], v[82:83]
    v_pk_mul_f32 v[184:185], v[184:185], v[84:85]
    v_pk_mul_f32 v[186:187], v[186:187], v[86:87]
    v_pk_mul_f32 v[188:189], v[188:189], v[88:89]
    v_pk_mul_f32 v[190:191], v[190:191], v[90:91]
    v_pk_mul_f32 v[192:193], v[192:193], v[92:93]
    v_pk_mul_f32 v[194:195], v[194:195], v[94:95]
    v_cvt_pk_bf16_f32 v204, v180, v181
    v_cvt_pk_bf16_f32 v205, v182, v183
    v_cvt_pk_bf16_f32 v206, v184, v185
    v_cvt_pk_bf16_f32 v207, v186, v187
    buffer_store_dwordx4 v[204:207], v2, s[56:59], s92 offen offset:2048 sc1
    v_cvt_pk_bf16_f32 v208, v188, v189
    v_cvt_pk_bf16_f32 v209, v190, v191
    v_cvt_pk_bf16_f32 v210, v192, v193
    v_cvt_pk_bf16_f32 v211, v194, v195
    buffer_store_dwordx4 v[208:211], v2, s[56:59], s92 offen offset:3072 sc1
    v_pk_mul_f32 v[180:181], v[96:97], v[30:31]
    v_pk_mul_f32 v[182:183], v[98:99], v[30:31]
    v_pk_mul_f32 v[184:185], v[100:101], v[30:31]
    v_pk_mul_f32 v[186:187], v[102:103], v[30:31]
    v_pk_mul_f32 v[188:189], v[104:105], v[30:31]
    v_pk_mul_f32 v[190:191], v[106:107], v[30:31]
    v_pk_mul_f32 v[192:193], v[108:109], v[30:31]
    v_pk_mul_f32 v[194:195], v[110:111], v[30:31]
    v_exp_f32 v180, v180
    v_exp_f32 v181, v181
    v_exp_f32 v182, v182
    v_exp_f32 v183, v183
    v_exp_f32 v184, v184
    v_exp_f32 v185, v185
    v_exp_f32 v186, v186
    v_exp_f32 v187, v187
    v_exp_f32 v188, v188
    v_exp_f32 v189, v189
    v_exp_f32 v190, v190
    v_exp_f32 v191, v191
    v_exp_f32 v192, v192
    v_exp_f32 v193, v193
    v_exp_f32 v194, v194
    v_exp_f32 v195, v195
    v_pk_fma_f32 v[180:181], v[180:181], v[32:33], v[32:33]
    v_pk_fma_f32 v[182:183], v[182:183], v[32:33], v[32:33]
    v_pk_fma_f32 v[184:185], v[184:185], v[32:33], v[32:33]
    v_pk_fma_f32 v[186:187], v[186:187], v[32:33], v[32:33]
    v_pk_fma_f32 v[188:189], v[188:189], v[32:33], v[32:33]
    v_pk_fma_f32 v[190:191], v[190:191], v[32:33], v[32:33]
    v_pk_fma_f32 v[192:193], v[192:193], v[32:33], v[32:33]
    v_pk_fma_f32 v[194:195], v[194:195], v[32:33], v[32:33]
    v_rcp_f32 v180, v180
    v_rcp_f32 v181, v181
    v_rcp_f32 v182, v182
    v_rcp_f32 v183, v183
    v_rcp_f32 v184, v184
    v_rcp_f32 v185, v185
    v_rcp_f32 v186, v186
    v_rcp_f32 v187, v187
    v_rcp_f32 v188, v188
    v_rcp_f32 v189, v189
    v_rcp_f32 v190, v190
    v_rcp_f32 v191, v191
    v_rcp_f32 v192, v192
    v_rcp_f32 v193, v193
    v_rcp_f32 v194, v194
    v_rcp_f32 v195, v195
    v_pk_mul_f32 v[180:181], v[180:181], v[96:97]
    v_pk_mul_f32 v[182:183], v[182:183], v[98:99]
    v_pk_mul_f32 v[184:185], v[184:185], v[100:101]
    v_pk_mul_f32 v[186:187], v[186:187], v[102:103]
    v_pk_mul_f32 v[188:189], v[188:189], v[104:105]
    v_pk_mul_f32 v[190:191], v[190:191], v[106:107]
    v_pk_mul_f32 v[192:193], v[192:193], v[108:109]
    v_pk_mul_f32 v[194:195], v[194:195], v[110:111]
    ds_write_b32 v6, v8 offset:16
    v_cvt_pk_bf16_f32 v212, v180, v181
    v_cvt_pk_bf16_f32 v213, v182, v183
    v_cvt_pk_bf16_f32 v214, v184, v185
    v_cvt_pk_bf16_f32 v215, v186, v187
    buffer_store_dwordx4 v[212:215], v2, s[60:63], s93 offen offset:0 sc1
    v_cvt_pk_bf16_f32 v216, v188, v189
    v_cvt_pk_bf16_f32 v217, v190, v191
    v_cvt_pk_bf16_f32 v218, v192, v193
    v_cvt_pk_bf16_f32 v219, v194, v195
    buffer_store_dwordx4 v[216:219], v2, s[60:63], s93 offen offset:1024 sc1
    s_add_u32 m0, s79, 32768
    s_nop 0
    buffer_load_dwordx4 v251, s[48:51], s84 offen lds
    s_add_u32 s84, s84, 65536
    s_cmp_ge_u32 s84, s86
    s_cselect_b32 s84, s85, s84
    s_add_u32 m0, s79, 36864
    s_nop 0
    buffer_load_dwordx4 v248, s[48:51], s84 offen lds
    s_add_u32 m0, s79, 40960
    s_nop 0
    buffer_load_dwordx4 v249, s[48:51], s84 offen lds
    s_add_u32 m0, s79, 45056
    s_nop 0
    buffer_load_dwordx4 v250, s[48:51], s84 offen lds
    s_add_u32 m0, s79, 49152
    s_nop 0
    buffer_load_dwordx4 v251, s[48:51], s84 offen lds
    s_add_u32 s84, s84, 65536
    s_cmp_ge_u32 s84, s86
    s_cselect_b32 s84, s85, s84
    s_add_u32 m0, s79, 53248
    s_nop 0
    buffer_load_dwordx4 v248, s[48:51], s84 offen lds
    s_waitcnt vmcnt(6)
    s_mov_b32 exec_hi, 0
    buffer_store_dword v3, v0, s[56:59], s19 offen sc1
    s_mov_b32 exec_hi, -1
    s_setprio 0
    s_add_u32 m0, s79, 57344
    s_nop 0
    buffer_load_dwordx4 v249, s[48:51], s84 offen lds
    s_add_u32 m0, s79, 61440
    s_nop 0
    buffer_load_dwordx4 v250, s[48:51], s84 offen lds
    ds_read_b32 v9, v7 offset:48
    s_waitcnt lgkmcnt(0)
    v_cmp_ne_u32 vcc, 1, v9
    s_nop 1
    s_cbranch_vccnz LSLC7
LOKC5:
    ds_read_b64_tr_b16 v[76:77], v14 offset:16384
    ds_read_b64_tr_b16 v[78:79], v14 offset:17408
    ds_read_b64_tr_b16 v[80:81], v15 offset:16384
    ds_read_b64_tr_b16 v[82:83], v15 offset:17408
    s_add_u32 m0, s79, 65536
    s_nop 0
    buffer_load_dwordx4 v251, s[48:51], s84 offen lds
    s_add_u32 s84, s84, 65536
    s_cmp_ge_u32 s84, s86
    s_cselect_b32 s84, s85, s84
    ds_read_b64_tr_b16 v[84:85], v14 offset:20480
    ds_read_b64_tr_b16 v[86:87], v14 offset:21504
    ds_read_b64_tr_b16 v[88:89], v15 offset:20480
    ds_read_b64_tr_b16 v[90:91], v15 offset:21504
    s_add_u32 m0, s79, 69632
    s_nop 0
    buffer_load_dwordx4 v248, s[48:51], s84 offen lds
    ds_read_b64_tr_b16 v[92:93], v10 offset:0
    ds_read_b64_tr_b16 v[94:95], v10 offset:1024
    ds_read_b64_tr_b16 v[96:97], v11 offset:0
    ds_read_b64_tr_b16 v[98:99], v11 offset:1024
    s_add_u32 m0, s79, 73728
    s_nop 0
    buffer_load_dwordx4 v249, s[48:51], s84 offen lds
    ds_read_b64_tr_b16 v[100:101], v10 offset:4096
    ds_read_b64_tr_b16 v[102:103], v10 offset:5120
    ds_read_b64_tr_b16 v[104:105], v11 offset:4096
    ds_read_b64_tr_b16 v[106:107], v11 offset:5120
    s_add_u32 m0, s79, 77824
    s_nop 0
    buffer_load_dwordx4 v250, s[48:51], s84 offen lds
    ds_read_b64_tr_b16 v[108:109], v10 offset:8192
    ds_read_b64_tr_b16 v[110:111], v10 offset:9216
    ds_read_b64_tr_b16 v[112:113], v11 offset:8192
    ds_read_b64_tr_b16 v[114:115], v11 offset:9216
    s_add_u32 m0, s79, 81920
    s_nop 0
    buffer_load_dwordx4 v251, s[48:51], s84 offen lds
    s_add_u32 s84, s84, 65536
    s_cmp_ge_u32 s84, s86
    s_cselect_b32 s84, s85, s84
    ds_read_b64_tr_b16 v[116:117], v10 offset:12288
    ds_read_b64_tr_b16 v[118:119], v10 offset:13312
    ds_read_b64_tr_b16 v[120:121], v11 offset:12288
    ds_read_b64_tr_b16 v[122:123], v11 offset:13312
    s_add_u32 m0, s79, 86016
    s_nop 0
    buffer_load_dwordx4 v248, s[48:51], s84 offen lds
    ds_read_b64_tr_b16 v[124:125], v10 offset:16384
    ds_read_b64_tr_b16 v[126:127], v10 offset:17408
    ds_read_b64_tr_b16 v[128:129], v11 offset:16384
    ds_read_b64_tr_b16 v[130:131], v11 offset:17408
    s_add_u32 m0, s79, 90112
    s_nop 0
    buffer_load_dwordx4 v249, s[48:51], s84 offen lds
    ds_read_b64_tr_b16 v[132:133], v10 offset:20480
    ds_read_b64_tr_b16 v[134:135], v10 offset:21504
    ds_read_b64_tr_b16 v[136:137], v11 offset:20480
    ds_read_b64_tr_b16 v[138:139], v11 offset:21504
    s_add_u32 m0, s79, 94208
    s_nop 0
    buffer_load_dwordx4 v250, s[48:51], s84 offen lds
    ds_read_b64_tr_b16 v[140:141], v10 offset:24576
    ds_read_b64_tr_b16 v[142:143], v10 offset:25600
    ds_read_b64_tr_b16 v[144:145], v11 offset:24576
    ds_read_b64_tr_b16 v[146:147], v11 offset:25600
    s_add_u32 m0, s79, 98304
    s_nop 0
    buffer_load_dwordx4 v251, s[48:51], s84 offen lds
    s_add_u32 s84, s84, 65536
    s_cmp_ge_u32 s84, s86
    s_cselect_b32 s84, s85, s84
    ds_read_b64_tr_b16 v[148:149], v10 offset:28672
    ds_read_b64_tr_b16 v[150:151], v10 offset:29696
    ds_read_b64_tr_b16 v[152:153], v11 offset:28672
    ds_read_b64_tr_b16 v[154:155], v11 offset:29696
    ds_write_b32 v6, v8 offset:64
    s_add_u32 m0, s79, 102400
    s_nop 0
    buffer_load_dwordx4 v248, s[48:51], s84 offen lds
    s_add_u32 m0, s79, 106496
    s_nop 0
    buffer_load_dwordx4 v249, s[48:51], s84 offen lds
    s_add_u32 m0, s79, 110592
    s_nop 0
    buffer_load_dwordx4 v250, s[48:51], s84 offen lds
    ds_read_b32 v9, v7 offset:64
    s_waitcnt lgkmcnt(0)
    v_cmp_ne_u32 vcc, 1, v9
    s_nop 1
    s_cbranch_vccnz LSLC10
LOKC8:
    buffer_load_dword v4, v5, s[56:59], s17 offen sc1
    s_add_u32 m0, s79, 114688
    s_nop 0
    buffer_load_dwordx4 v251, s[48:51], s84 offen lds
    s_add_u32 s84, s84, 65536
    s_cmp_ge_u32 s84, s86
    s_cselect_b32 s84, s85, s84
    s_add_u32 m0, s79, 118784
    s_nop 0
    buffer_load_dwordx4 v248, s[48:51], s84 offen lds
    s_add_u32 m0, s79, 0
    s_nop 0
    buffer_load_dwordx4 v249, s[48:51], s84 offen lds
    s_add_u32 m0, s79, 4096
    s_nop 0
    buffer_load_dwordx4 v250, s[48:51], s84 offen lds
    s_waitcnt vmcnt(4)
    v_cmp_ne_u32 vcc, s74, v4
    s_nop 1
    s_cbranch_vccnz LSLOWC13
LOKC11:
    buffer_load_dwordx4 v[156:159], v2, s[56:59], s89 offen offset:0 sc1
    buffer_load_dwordx4 v[160:163], v2, s[56:59], s89 offen offset:1024 sc1
    buffer_load_dwordx4 v[164:167], v2, s[56:59], s89 offen offset:2048 sc1
    buffer_load_dwordx4 v[168:171], v2, s[56:59], s87 offen offset:0 sc1
    buffer_load_dwordx4 v[172:175], v2, s[56:59], s87 offen offset:1024 sc1
    buffer_load_dwordx4 v[176:179], v2, s[56:59], s87 offen offset:2048 sc1
    buffer_load_dwordx4 v[180:183], v2, s[56:59], s87 offen offset:3072 sc1
    s_add_u32 s87, s87, 4096
    s_cmp_ge_u32 s87, s89
    s_cselect_b32 s87, s88, s87
    buffer_load_dwordx4 v[184:187], v2, s[56:59], s87 offen offset:0 sc1
    buffer_load_dwordx4 v[188:191], v2, s[56:59], s87 offen offset:1024 sc1
    buffer_load_dwordx4 v[192:195], v2, s[56:59], s87 offen offset:2048 sc1
    s_setprio 0
    s_waitcnt vmcnt(9)
    v_mfma_f32_32x32x16_bf16 v[20:35], v[76:79], v[156:159], 0
    s_add_u32 m0, s79, 8192
    s_nop 0
    buffer_load_dwordx4 v251, s[48:51], s84 offen lds
    v_mfma_f32_32x32x16_bf16 v[36:51], v[80:83], v[156:159], 0
    s_add_u32 s84, s84, 65536
    s_cmp_ge_u32 s84, s86
    s_cselect_b32 s84, s85, s84
    buffer_load_dwordx4 v[196:199], v2, s[56:59], s87 offen offset:3072 sc1
    s_add_u32 s87, s87, 4096
    s_cmp_ge_u32 s87, s89
    s_cselect_b32 s87, s88, s87
    buffer_load_dwordx4 v[200:203], v2, s[56:59], s87 offen offset:0 sc1
    s_waitcnt vmcnt(11)
    v_mfma_f32_32x32x16_bf16 v[20:35], v[84:87], v[160:163], v[20:35]
    ds_write_b32 v6, v8 offset:112
    s_add_u32 m0, s79, 12288
    s_nop 0
    buffer_load_dwordx4 v248, s[48:51], s84 offen lds
    v_mfma_f32_32x32x16_bf16 v[36:51], v[88:91], v[160:163], v[36:51]
    buffer_load_dwordx4 v[204:207], v2, s[56:59], s87 offen offset:1024 sc1
    buffer_load_dwordx4 v[208:211], v2, s[56:59], s87 offen offset:2048 sc1
    s_waitcnt vmcnt(13)
    v_mfma_f32_32x32x16_bf16 v[20:35], v[92:95], v[164:167], v[20:35]
    s_add_u32 m0, s79, 16384
    s_nop 0
    buffer_load_dwordx4 v249, s[48:51], s84 offen lds
    v_mfma_f32_32x32x16_bf16 v[36:51], v[96:99], v[164:167], v[36:51]
    buffer_load_dwordx4 v[212:215], v2, s[56:59], s87 offen offset:3072 sc1
    s_add_u32 s87, s87, 4096
    s_cmp_ge_u32 s87, s89
    s_cselect_b32 s87, s88, s87
    buffer_load_dwordx4 v[216:219], v2, s[56:59], s87 offen offset:0 sc1
    s_waitcnt vmcnt(15)
    v_mfma_f32_32x32x16_bf16 v[20:35], v[100:103], v[168:171], v[20:35]
    s_add_u32 m0, s79, 20480
    s_nop 0
    buffer_load_dwordx4 v250, s[48:51], s84 offen lds
    v_mfma_f32_32x32x16_bf16 v[36:51], v[104:107], v[168:171], v[36:51]
    buffer_load_dwordx4 v[220:223], v2, s[56:59], s87 offen offset:1024 sc1
    buffer_load_dwordx4 v[224:227], v2, s[56:59], s87 offen offset:2048 sc1
    s_waitcnt vmcnt(17)
    v_mfma_f32_32x32x16_bf16 v[20:35], v[108:111], v[172:175], v[20:35]
    s_add_u32 m0, s79, 24576
    s_nop 0
    buffer_load_dwordx4 v251, s[48:51], s84 offen lds
    v_mfma_f32_32x32x16_bf16 v[36:51], v[112:115], v[172:175], v[36:51]
    s_add_u32 s84, s84, 65536
    s_cmp_ge_u32 s84, s86
    s_cselect_b32 s84, s85, s84
    buffer_load_dwordx4 v[228:231], v2, s[56:59], s87 offen offset:3072 sc1
    s_add_u32 s87, s87, 4096
    s_cmp_ge_u32 s87, s89
    s_cselect_b32 s87, s88, s87
    ds_read_b32 v9, v7 offset:112
    s_waitcnt vmcnt(18)
    v_mfma_f32_32x32x16_bf16 v[20:35], v[116:119], v[176:179], v[20:35]
    s_add_u32 m0, s79, 28672
    s_nop 0
    buffer_load_dwordx4 v248, s[48:51], s84 offen lds
    v_mfma_f32_32x32x16_bf16 v[36:51], v[120:123], v[176:179], v[36:51]
    buffer_load_dwordx4 v[232:235], v2, s[56:59], s87 offen offset:0 sc1
    s_waitcnt vmcnt(19)
    v_mfma_f32_32x32x16_bf16 v[20:35], v[124:127], v[180:183], v[20:35]
    buffer_load_dwordx4 v[236:239], v2, s[56:59], s87 offen offset:1024 sc1
    v_mfma_f32_32x32x16_bf16 v[36:51], v[128:131], v[180:183], v[36:51]
    s_waitcnt vmcnt(19)
    v_mfma_f32_32x32x16_bf16 v[20:35], v[132:135], v[184:187], v[20:35]
    buffer_load_dwordx4 v[240:243], v2, s[56:59], s87 offen offset:2048 sc1
    v_mfma_f32_32x32x16_bf16 v[36:51], v[136:139], v[184:187], v[36:51]
    s_waitcnt lgkmcnt(0)
    v_cmp_ne_u32 vcc, 1, v9
    s_nop 1
    s_cbranch_vccnz LSLC16
LOKC14:
    s_waitcnt vmcnt(19)
    v_mfma_f32_32x32x16_bf16 v[20:35], v[140:143], v[188:191], v[20:35]
    ds_read_b64_tr_b16 v[60:61], v10 offset:32768
    ds_read_b64_tr_b16 v[62:63], v10 offset:33792
    buffer_load_dwordx4 v[244:247], v2, s[56:59], s87 offen offset:3072 sc1
    s_add_u32 s87, s87, 4096
    v_mfma_f32_32x32x16_bf16 v[36:51], v[144:147], v[188:191], v[36:51]
    ds_read_b64_tr_b16 v[64:65], v11 offset:32768
    ds_read_b64_tr_b16 v[66:67], v11 offset:33792
    s_cmp_ge_u32 s87, s89
    s_cselect_b32 s87, s88, s87
    s_waitcnt vmcnt(19)
    v_mfma_f32_32x32x16_bf16 v[20:35], v[148:151], v[192:195], v[20:35]
    ds_read_b64_tr_b16 v[68:69], v10 offset:36864
    ds_read_b64_tr_b16 v[70:71], v10 offset:37888
    buffer_load_dwordx4 v[156:159], v2, s[56:59], s87 offen offset:0 sc1
    v_mfma_f32_32x32x16_bf16 v[36:51], v[152:155], v[192:195], v[36:51]
    ds_read_b64_tr_b16 v[72:73], v11 offset:36864
    ds_read_b64_tr_b16 v[74:75], v11 offset:37888
    s_waitcnt vmcnt(18) lgkmcnt(6)
    v_mfma_f32_32x32x16_bf16 v[20:35], v[60:63], v[196:199], v[20:35]
    ds_read_b64_tr_b16 v[52:53], v10 offset:40960
    ds_read_b64_tr_b16 v[54:55], v10 offset:41984
    buffer_load_dwordx4 v[160:163], v2, s[56:59], s87 offen offset:1024 sc1
    s_waitcnt lgkmcnt(6)
    v_mfma_f32_32x32x16_bf16 v[36:51], v[64:67], v[196:199], v[36:51]
    ds_read_b64_tr_b16 v[56:57], v11 offset:40960
    ds_read_b64_tr_b16 v[58:59], v11 offset:41984
    s_waitcnt vmcnt(18) lgkmcnt(6)
    v_mfma_f32_32x32x16_bf16 v[20:35], v[68:71], v[200:203], v[20:35]
    ds_read_b64_tr_b16 v[60:61], v10 offset:45056
    ds_read_b64_tr_b16 v[62:63], v10 offset:46080
    buffer_load_dwordx4 v[164:167], v2, s[56:59], s87 offen offset:2048 sc1
    s_waitcnt lgkmcnt(6)
    v_mfma_f32_32x32x16_bf16 v[36:51], v[72:75], v[200:203], v[36:51]
    ds_read_b64_tr_b16 v[64:65], v11 offset:45056
    ds_read_b64_tr_b16 v[66:67], v11 offset:46080
    s_waitcnt vmcnt(17) lgkmcnt(6)
    v_mfma_f32_32x32x16_bf16 v[20:35], v[52:55], v[204:207], v[20:35]
    ds_read_b64_tr_b16 v[68:69], v12 offset:0
    ds_read_b64_tr_b16 v[70:71], v12 offset:1024
    buffer_load_dwordx4 v[168:171], v2, s[56:59], s87 offen offset:3072 sc1
    s_add_u32 s87, s87, 4096
    s_waitcnt lgkmcnt(6)
    v_mfma_f32_32x32x16_bf16 v[36:51], v[56:59], v[204:207], v[36:51]
    ds_read_b64_tr_b16 v[72:73], v13 offset:0
    ds_read_b64_tr_b16 v[74:75], v13 offset:1024
    s_cmp_ge_u32 s87, s89
    s_cselect_b32 s87, s88, s87
    ds_write_b32 v6, v8 offset:192
    s_waitcnt vmcnt(17) lgkmcnt(7)
    v_mfma_f32_32x32x16_bf16 v[20:35], v[60:63], v[208:211], v[20:35]
    ds_read_b64_tr_b16 v[52:53], v12 offset:4096
    ds_read_b64_tr_b16 v[54:55], v12 offset:5120
    buffer_load_dwordx4 v[172:175], v2, s[56:59], s87 offen offset:0 sc1
    s_waitcnt lgkmcnt(7)
    v_mfma_f32_32x32x16_bf16 v[36:51], v[64:67], v[208:211], v[36:51]
    ds_read_b64_tr_b16 v[56:57], v13 offset:4096
    ds_read_b64_tr_b16 v[58:59], v13 offset:5120
    s_waitcnt vmcnt(16) lgkmcnt(7)
    v_mfma_f32_32x32x16_bf16 v[20:35], v[68:71], v[212:215], v[20:35]
    ds_read_b64_tr_b16 v[60:61], v12 offset:8192
    ds_read_b64_tr_b16 v[62:63], v12 offset:9216
    buffer_load_dwordx4 v[176:179], v2, s[56:59], s87 offen offset:1024 sc1
    s_waitcnt lgkmcnt(7)
    v_mfma_f32_32x32x16_bf16 v[36:51], v[72:75], v[212:215], v[36:51]
    ds_read_b64_tr_b16 v[64:65], v13 offset:8192
    ds_read_b64_tr_b16 v[66:67], v13 offset:9216
    s_waitcnt vmcnt(16) lgkmcnt(6)
    v_mfma_f32_32x32x16_bf16 v[20:35], v[52:55], v[216:219], v[20:35]
    ds_read_b64_tr_b16 v[68:69], v12 offset:12288
    ds_read_b64_tr_b16 v[70:71], v12 offset:13312
    buffer_load_dwordx4 v[180:183], v2, s[56:59], s87 offen offset:2048 sc1
    s_waitcnt lgkmcnt(6)
    v_mfma_f32_32x32x16_bf16 v[36:51], v[56:59], v[216:219], v[36:51]
    ds_read_b64_tr_b16 v[72:73], v13 offset:12288
    ds_read_b64_tr_b16 v[74:75], v13 offset:13312
    s_waitcnt vmcnt(15) lgkmcnt(6)
    v_mfma_f32_32x32x16_bf16 v[20:35], v[60:63], v[220:223], v[20:35]
    ds_read_b64_tr_b16 v[52:53], v12 offset:16384
    ds_read_b64_tr_b16 v[54:55], v12 offset:17408
    buffer_load_dwordx4 v[184:187], v2, s[56:59], s87 offen offset:3072 sc1
    s_add_u32 s87, s87, 4096
    s_waitcnt lgkmcnt(6)
    v_mfma_f32_32x32x16_bf16 v[36:51], v[64:67], v[220:223], v[36:51]
    ds_read_b64_tr_b16 v[56:57], v13 offset:16384
    ds_read_b64_tr_b16 v[58:59], v13 offset:17408
    s_cmp_ge_u32 s87, s89
    s_cselect_b32 s87, s88, s87
    s_waitcnt vmcnt(15) lgkmcnt(6)
    v_mfma_f32_32x32x16_bf16 v[20:35], v[68:71], v[224:227], v[20:35]
    ds_read_b64_tr_b16 v[60:61], v12 offset:20480
    ds_read_b64_tr_b16 v[62:63], v12 offset:21504
    buffer_load_dwordx4 v[188:191], v2, s[56:59], s87 offen offset:0 sc1
    s_waitcnt lgkmcnt(6)
    v_mfma_f32_32x32x16_bf16 v[36:51], v[72:75], v[224:227], v[36:51]
    ds_read_b64_tr_b16 v[64:65], v13 offset:20480
    ds_read_b64_tr_b16 v[66:67], v13 offset:21504
    s_waitcnt vmcnt(14) lgkmcnt(6)
    v_mfma_f32_32x32x16_bf16 v[20:35], v[52:55], v[228:231], v[20:35]
    ds_read_b64_tr_b16 v[68:69], v12 offset:24576
    ds_read_b64_tr_b16 v[70:71], v12 offset:25600
    buffer_load_dwordx4 v[192:195], v2, s[56:59], s87 offen offset:1024 sc1
    s_waitcnt lgkmcnt(6)
    v_mfma_f32_32x32x16_bf16 v[36:51], v[56:59], v[228:231], v[36:51]
    ds_read_b64_tr_b16 v[72:73], v13 offset:24576
    ds_read_b64_tr_b16 v[74:75], v13 offset:25600
    s_waitcnt vmcnt(13) lgkmcnt(6)
    v_mfma_f32_32x32x16_bf16 v[20:35], v[60:63], v[232:235], v[20:35]
    ds_read_b64_tr_b16 v[52:53], v12 offset:28672
    ds_read_b64_tr_b16 v[54:55], v12 offset:29696
    buffer_load_dwordx4 v[196:199], v2, s[56:59], s87 offen offset:2048 sc1
    s_waitcnt lgkmcnt(6)
    v_mfma_f32_32x32x16_bf16 v[36:51], v[64:67], v[232:235], v[36:51]
    ds_read_b64_tr_b16 v[56:57], v13 offset:28672
    ds_read_b64_tr_b16 v[58:59], v13 offset:29696
    s_waitcnt vmcnt(13) lgkmcnt(6)
    v_mfma_f32_32x32x16_bf16 v[20:35], v[68:71], v[236:239], v[20:35]
    ds_read_b64_tr_b16 v[60:61], v12 offset:32768
    ds_read_b64_tr_b16 v[62:63], v12 offset:33792
    buffer_load_dwordx4 v[200:203], v2, s[56:59], s87 offen offset:3072 sc1
    s_add_u32 s87, s87, 4096
    s_waitcnt lgkmcnt(6)
    v_mfma_f32_32x32x16_bf16 v[36:51], v[72:75], v[236:239], v[36:51]
    ds_read_b64_tr_b16 v[64:65], v13 offset:32768
    ds_read_b64_tr_b16 v[66:67], v13 offset:33792
    s_cmp_ge_u32 s87, s89
    s_cselect_b32 s87, s88, s87
    ds_write_b32 v6, v8 offset:240
    s_waitcnt vmcnt(13) lgkmcnt(7)
    v_mfma_f32_32x32x16_bf16 v[20:35], v[52:55], v[240:243], v[20:35]
    ds_read_b64_tr_b16 v[68:69], v12 offset:36864
    ds_read_b64_tr_b16 v[70:71], v12 offset:37888
    buffer_load_dwordx4 v[204:207], v2, s[56:59], s87 offen offset:0 sc1
    s_waitcnt lgkmcnt(7)
    v_mfma_f32_32x32x16_bf16 v[36:51], v[56:59], v[240:243], v[36:51]
    ds_read_b64_tr_b16 v[72:73], v13 offset:36864
    ds_read_b64_tr_b16 v[74:75], v13 offset:37888
    ds_write_b32 v6, v8 offset:208
    s_waitcnt vmcnt(13) lgkmcnt(8)
    v_mfma_f32_32x32x16_bf16 v[20:35], v[60:63], v[244:247], v[20:35]
    ds_read_b64_tr_b16 v[52:53], v12 offset:40960
    ds_read_b64_tr_b16 v[54:55], v12 offset:41984
    buffer_load_dwordx4 v[208:211], v2, s[56:59], s87 offen offset:1024 sc1
    s_waitcnt lgkmcnt(8)
    v_mfma_f32_32x32x16_bf16 v[36:51], v[64:67], v[244:247], v[36:51]
    ds_read_b64_tr_b16 v[56:57], v13 offset:40960
    ds_read_b64_tr_b16 v[58:59], v13 offset:41984
    s_waitcnt vmcnt(13) lgkmcnt(7)
    v_mfma_f32_32x32x16_bf16 v[20:35], v[68:71], v[156:159], v[20:35]
    ds_read_b64_tr_b16 v[60:61], v12 offset:45056
    ds_read_b64_tr_b16 v[62:63], v12 offset:46080
    buffer_load_dwordx4 v[212:215], v2, s[56:59], s87 offen offset:2048 sc1
    s_waitcnt lgkmcnt(7)
    v_mfma_f32_32x32x16_bf16 v[36:51], v[72:75], v[156:159], v[36:51]
    ds_read_b64_tr_b16 v[64:65], v13 offset:45056
    ds_read_b64_tr_b16 v[66:67], v13 offset:46080
    s_waitcnt vmcnt(13) lgkmcnt(6)
    v_mfma_f32_32x32x16_bf16 v[20:35], v[52:55], v[160:163], v[20:35]
    ds_read_b64_tr_b16 v[68:69], v14 offset:0
    ds_read_b64_tr_b16 v[70:71], v14 offset:1024
    buffer_load_dwordx4 v[216:219], v2, s[56:59], s87 offen offset:3072 sc1
    s_add_u32 s87, s87, 4096
    s_waitcnt lgkmcnt(6)
    v_mfma_f32_32x32x16_bf16 v[36:51], v[56:59], v[160:163], v[36:51]
    ds_read_b64_tr_b16 v[72:73], v15 offset:0
    ds_read_b64_tr_b16 v[74:75], v15 offset:1024
    s_cmp_ge_u32 s87, s89
    s_cselect_b32 s87, s88, s87
    s_waitcnt vmcnt(13) lgkmcnt(6)
    v_mfma_f32_32x32x16_bf16 v[20:35], v[60:63], v[164:167], v[20:35]
    ds_read_b64_tr_b16 v[52:53], v14 offset:4096
    ds_read_b64_tr_b16 v[54:55], v14 offset:5120
    buffer_load_dwordx4 v[220:223], v2, s[56:59], s87 offen offset:0 sc1
    s_waitcnt lgkmcnt(6)
    v_mfma_f32_32x32x16_bf16 v[36:51], v[64:67], v[164:167], v[36:51]
    ds_read_b64_tr_b16 v[56:57], v15 offset:4096
    ds_read_b64_tr_b16 v[58:59], v15 offset:5120
    s_waitcnt vmcnt(13) lgkmcnt(6)
    v_mfma_f32_32x32x16_bf16 v[20:35], v[68:71], v[168:171], v[20:35]
    ds_read_b64_tr_b16 v[60:61], v14 offset:8192
    ds_read_b64_tr_b16 v[62:63], v14 offset:9216
    buffer_load_dwordx4 v[224:227], v2, s[56:59], s87 offen offset:1024 sc1
    s_waitcnt lgkmcnt(6)
    v_mfma_f32_32x32x16_bf16 v[36:51], v[72:75], v[168:171], v[36:51]
    ds_read_b64_tr_b16 v[64:65], v15 offset:8192
    ds_read_b64_tr_b16 v[66:67], v15 offset:9216
    s_waitcnt vmcnt(13) lgkmcnt(6)
    v_mfma_f32_32x32x16_bf16 v[20:35], v[52:55], v[172:175], v[20:35]
    ds_read_b64_tr_b16 v[68:69], v14 offset:12288
    ds_read_b64_tr_b16 v[70:71], v14 offset:13312
    buffer_load_dwordx4 v[228:231], v2, s[56:59], s87 offen offset:2048 sc1
    s_waitcnt lgkmcnt(6)
    v_mfma_f32_32x32x16_bf16 v[36:51], v[56:59], v[172:175], v[36:51]
    ds_read_b64_tr_b16 v[72:73], v15 offset:12288
    ds_read_b64_tr_b16 v[74:75], v15 offset:13312
    s_waitcnt vmcnt(13) lgkmcnt(6)
    v_mfma_f32_32x32x16_bf16 v[20:35], v[60:63], v[176:179], v[20:35]
    ds_read_b64_tr_b16 v[52:53], v14 offset:16384
    ds_read_b64_tr_b16 v[54:55], v14 offset:17408
    buffer_load_dwordx4 v[232:235], v2, s[56:59], s87 offen offset:3072 sc1
    s_waitcnt lgkmcnt(6)
    v_mfma_f32_32x32x16_bf16 v[36:51], v[64:67], v[176:179], v[36:51]
    ds_read_b64_tr_b16 v[56:57], v15 offset:16384
    ds_read_b64_tr_b16 v[58:59], v15 offset:17408
    ds_read_b32 v9, v7 offset:240
    s_waitcnt vmcnt(13) lgkmcnt(7)
    v_mfma_f32_32x32x16_bf16 v[20:35], v[68:71], v[180:183], v[20:35]
    ds_read_b64_tr_b16 v[60:61], v14 offset:20480
    ds_read_b64_tr_b16 v[62:63], v14 offset:21504
    s_waitcnt lgkmcnt(7)
    v_mfma_f32_32x32x16_bf16 v[36:51], v[72:75], v[180:183], v[36:51]
    ds_read_b64_tr_b16 v[64:65], v15 offset:20480
    ds_read_b64_tr_b16 v[66:67], v15 offset:21504
    s_waitcnt vmcnt(12) lgkmcnt(7)
    v_mfma_f32_32x32x16_bf16 v[20:35], v[52:55], v[184:187], v[20:35]
    ds_read_b64_tr_b16 v[68:69], v10 offset:0
    ds_read_b64_tr_b16 v[70:71], v10 offset:1024
    s_waitcnt lgkmcnt(7)
    v_mfma_f32_32x32x16_bf16 v[36:51], v[56:59], v[184:187], v[36:51]
    ds_read_b64_tr_b16 v[72:73], v11 offset:0
    ds_read_b64_tr_b16 v[74:75], v11 offset:1024
    s_waitcnt vmcnt(11) lgkmcnt(6)
    v_mfma_f32_32x32x16_bf16 v[20:35], v[60:63], v[188:191], v[20:35]
    ds_read_b64_tr_b16 v[52:53], v10 offset:4096
    ds_read_b64_tr_b16 v[54:55], v10 offset:5120
    s_waitcnt lgkmcnt(6)
    v_mfma_f32_32x32x16_bf16 v[36:51], v[64:67], v[188:191], v[36:51]
    ds_read_b64_tr_b16 v[56:57], v11 offset:4096
    ds_read_b64_tr_b16 v[58:59], v11 offset:5120
    v_cmp_ne_u32 vcc, 1, v9
    s_nop 1
    s_cbranch_vccnz LSLC19
LOKC17:
    s_waitcnt vmcnt(10) lgkmcnt(6)
    v_mfma_f32_32x32x16_bf16 v[20:35], v[68:71], v[192:195], v[20:35]
    ds_read_b64_tr_b16 v[60:61], v10 offset:8192
    ds_read_b64_tr_b16 v[62:63], v10 offset:9216
    s_waitcnt lgkmcnt(6)
    v_mfma_f32_32x32x16_bf16 v[36:51], v[72:75], v[192:195], v[36:51]
    ds_read_b64_tr_b16 v[64:65], v11 offset:8192
    ds_read_b64_tr_b16 v[66:67], v11 offset:9216
    s_waitcnt vmcnt(9) lgkmcnt(6)
    v_mfma_f32_32x32x16_bf16 v[20:35], v[52:55], v[196:199], v[20:35]
    ds_read_b64_tr_b16 v[68:69], v10 offset:12288
    ds_read_b64_tr_b16 v[70:71], v10 offset:13312
    s_waitcnt lgkmcnt(6)
    v_mfma_f32_32x32x16_bf16 v[36:51], v[56:59], v[196:199], v[36:51]
    ds_read_b64_tr_b16 v[72:73], v11 offset:12288
    ds_read_b64_tr_b16 v[74:75], v11 offset:13312
    s_waitcnt vmcnt(8) lgkmcnt(6)
    v_mfma_f32_32x32x16_bf16 v[20:35], v[60:63], v[200:203], v[20:35]
    ds_read_b64_tr_b16 v[52:53], v10 offset:16384
    ds_read_b64_tr_b16 v[54:55], v10 offset:17408
    s_waitcnt lgkmcnt(6)
    v_mfma_f32_32x32x16_bf16 v[36:51], v[64:67], v[200:203], v[36:51]
    ds_read_b64_tr_b16 v[56:57], v11 offset:16384
    ds_read_b64_tr_b16 v[58:59], v11 offset:17408
    ds_read_b32 v9, v7 offset:128
    s_waitcnt vmcnt(7) lgkmcnt(7)
    v_mfma_f32_32x32x16_bf16 v[20:35], v[68:71], v[204:207], v[20:35]
    ds_read_b64_tr_b16 v[76:77], v10 offset:20480
    ds_read_b64_tr_b16 v[78:79], v10 offset:21504
    s_waitcnt lgkmcnt(7)
    v_mfma_f32_32x32x16_bf16 v[36:51], v[72:75], v[204:207], v[36:51]
    ds_read_b64_tr_b16 v[80:81], v11 offset:20480
    ds_read_b64_tr_b16 v[82:83], v11 offset:21504
    s_waitcnt vmcnt(6) lgkmcnt(7)
    v_mfma_f32_32x32x16_bf16 v[20:35], v[52:55], v[208:211], v[20:35]
    ds_read_b64_tr_b16 v[84:85], v10 offset:24576
    ds_read_b64_tr_b16 v[86:87], v10 offset:25600
    s_waitcnt lgkmcnt(7)
    v_mfma_f32_32x32x16_bf16 v[36:51], v[56:59], v[208:211], v[36:51]
    ds_read_b64_tr_b16 v[88:89], v11 offset:24576
    ds_read_b64_tr_b16 v[90:91], v11 offset:25600
    s_waitcnt vmcnt(5) lgkmcnt(4)
    v_mfma_f32_32x32x16_bf16 v[36:51], v[80:83], v[212:215], v[36:51]
    ds_read_b64_tr_b16 v[92:93], v10 offset:28672
    ds_read_b64_tr_b16 v[94:95], v10 offset:29696
    ds_read_b64_tr_b16 v[96:97], v11 offset:28672
    ds_read_b64_tr_b16 v[98:99], v11 offset:29696
    v_cmp_ne_u32 vcc, 1, v9
    s_nop 1
    s_cbranch_vccnz LSLC22
LOKC20:
    s_waitcnt vmcnt(4) lgkmcnt(4)
    v_mfma_f32_32x32x16_bf16 v[36:51], v[88:91], v[216:219], v[36:51]
    ds_read_b64_tr_b16 v[100:101], v14 offset:27392
    ds_read_b64_tr_b16 v[102:103], v14 offset:28416
    ds_read_b64_tr_b16 v[104:105], v15 offset:27392
    ds_read_b64_tr_b16 v[106:107], v15 offset:28416
    ds_read_b32 v18, v7 offset:208
    s_waitcnt vmcnt(3) lgkmcnt(5)
    v_mfma_f32_32x32x16_bf16 v[36:51], v[96:99], v[220:223], v[36:51]
    ds_read_b64_tr_b16 v[108:109], v14 offset:31488
    ds_read_b64_tr_b16 v[110:111], v14 offset:32512
    ds_read_b64_tr_b16 v[112:113], v15 offset:31488
    ds_read_b64_tr_b16 v[114:115], v15 offset:32512
    s_waitcnt vmcnt(2) lgkmcnt(5)
    v_mfma_f32_32x32x16_bf16 v[36:51], v[104:107], v[224:227], v[36:51]
    ds_read_b64_tr_b16 v[116:117], v14 offset:35584
    ds_read_b64_tr_b16 v[118:119], v14 offset:36608
    ds_read_b64_tr_b16 v[120:121], v15 offset:35584
    ds_read_b64_tr_b16 v[122:123], v15 offset:36608
    s_waitcnt vmcnt(1) lgkmcnt(4)
    v_mfma_f32_32x32x16_bf16 v[36:51], v[112:115], v[228:231], v[36:51]
    v_cmp_ne_u32 vcc, 1, v18
    s_nop 1
    s_cbranch_vccnz LSLC25
LOKC23:
    s_waitcnt vmcnt(0) lgkmcnt(0)
    v_mfma_f32_32x32x16_bf16 v[36:51], v[120:123], v[232:235], v[36:51]
    v_mfma_f32_32x32x16_bf16 v[20:35], v[76:79], v[212:215], v[20:35]
    v_mfma_f32_32x32x16_bf16 v[20:35], v[84:87], v[216:219], v[20:35]
    v_mfma_f32_32x32x16_bf16 v[20:35], v[92:95], v[220:223], v[20:35]
    s_nop 8
    ds_write_b128 v17, v[36:39] offset:0
    v_mfma_f32_32x32x16_bf16 v[20:35], v[100:103], v[224:227], v[20:35]
    ds_write_b128 v17, v[40:43] offset:32
    v_mfma_f32_32x32x16_bf16 v[20:35], v[108:111], v[228:231], v[20:35]
    ds_write_b128 v17, v[44:47] offset:64
    v_mfma_f32_32x32x16_bf16 v[20:35], v[116:119], v[232:235], v[20:35]
    ds_write_b128 v17, v[48:51] offset:96
    s_nop 10
    ds_write_b128 v16, v[20:23] offset:0
    ds_write_b128 v16, v[24:27] offset:32
    ds_write_b128 v16, v[28:31] offset:64
    ds_write_b128 v16, v[32:35] offset:96
    s_waitcnt lgkmcnt(0)
    s_barrier
    s_endpgm
LSLOWH3:
    s_mov_b32 s90, 30000
LPOLLH2:
    s_sleep 4
    buffer_load_dword v4, v15, s[56:59], s16 offen sc1
    s_sub_u32 s90, s90, 1
    s_waitcnt vmcnt(0)
    s_cbranch_scc1 LOKH1
    v_cmp_ne_u32 vcc, s74, v4
    s_nop 1
    s_cbranch_vccnz LPOLLH2
    s_branch LOKH1
LSLH6:
    s_mov_b32 s90, 300000
LSPH5:
    ds_read_b32 v46, v9 offset:32
    s_sub_u32 s90, s90, 1
    s_waitcnt lgkmcnt(0)
    s_cbranch_scc1 LOKH4
    v_cmp_ne_u32 vcc, 1, v46
    s_nop 1
    s_cbranch_vccnz LSPH5
    s_branch LOKH4
LEH7:
    buffer_load_dword v44, v43, s[56:59], s26 offen sc1
    s_branch LBH8
LSLH11:
    s_mov_b32 s90, 300000
LSPH10:
    ds_read_b32 v46, v6 offset:16
    s_sub_u32 s90, s90, 1
    s_waitcnt lgkmcnt(0)
    s_cbranch_scc1 LOKH9
    v_cmp_ne_u32 vcc, 1, v46
    s_nop 1
    s_cbranch_vccnz LSPH10
    s_branch LOKH9
LSLH14:
    s_mov_b32 s90, 300000
LSPH13:
    ds_read_b32 v47, v9 offset:80
    s_sub_u32 s90, s90, 1
    s_waitcnt lgkmcnt(0)
    s_cbranch_scc1 LOKH12
    v_cmp_ne_u32 vcc, 1, v47
    s_nop 1
    s_cbranch_vccnz LSPH13
    s_branch LOKH12
LSLH19:
    s_mov_b32 s90, 300000
LSPH18:
    ds_read_b32 v46, v9 offset:96
    s_sub_u32 s90, s90, 1
    s_waitcnt lgkmcnt(0)
    s_cbranch_scc1 LOKH17
    v_cmp_ne_u32 vcc, 1, v46
    s_nop 1
    s_cbranch_vccnz LSPH18
    s_branch LOKH17
LSLH22:
    s_mov_b32 s90, 300000
LSPH21:
    ds_read_b32 v46, v7 offset:176
    s_sub_u32 s90, s90, 1
    s_waitcnt lgkmcnt(0)
    s_cbranch_scc1 LOKH20
    v_cmp_ne_u32 vcc, 1, v46
    s_nop 1
    s_cbranch_vccnz LSPH21
    s_branch LOKH20
LSLH29:
    s_mov_b32 s90, 300000
LSPH28:
    ds_read_b32 v46, v7 offset:160
    s_sub_u32 s90, s90, 1
    s_waitcnt lgkmcnt(0)
    s_cbranch_scc1 LOKH27
    v_cmp_ne_u32 vcc, 1, v46
    s_nop 1
    s_cbranch_vccnz LSPH28
    s_branch LOKH27
LEH23:
    s_mov_b32 s90, 30000
LPH25:
    v_cmp_ne_u32 vcc, s74, v44
    s_nop 1
    s_cbranch_vccz LQH26
    buffer_load_dword v44, v43, s[56:59], s26 offen sc1
    s_sub_u32 s90, s90, 1
    s_waitcnt vmcnt(0)
    s_cbranch_scc0 LPH25
LQH26:
    ds_write_b32 v6, v8 offset:160
    s_cmp_lg_u32 s70, 0
    s_cbranch_scc1 LBH24
    ds_read_b32 v46, v7 offset:160
    s_waitcnt lgkmcnt(0)
    v_cmp_ne_u32 vcc, 1, v46
    s_nop 1
    s_cbranch_vccnz LSLH29
LOKH27:
    s_mov_b32 s81, 6160384
    s_mov_b64 exec, 1
    buffer_store_dword v3, off, s[56:59], s81 sc1
    s_mov_b64 exec, -1
    s_branch LBH24
LSLH32:
    s_mov_b32 s90, 300000
LSPH31:
    ds_read_b32 v46, v6 offset:192
    s_sub_u32 s90, s90, 1
    s_waitcnt lgkmcnt(0)
    s_cbranch_scc1 LOKH30
    v_cmp_ne_u32 vcc, 1, v46
    s_nop 1
    s_cbranch_vccnz LSPH31
    s_branch LOKH30
LSLOWH35:
    s_mov_b32 s90, 30000
LPOLLH34:
    s_sleep 4
    buffer_load_dword v4, v5, s[56:59], s18 offen sc1
    s_sub_u32 s90, s90, 1
    s_waitcnt vmcnt(0)
    s_cbranch_scc1 LOKH33
    v_cmp_ne_u32 vcc, s74, v4
    s_nop 1
    s_cbranch_vccnz LPOLLH34
    s_branch LOKH33
LSLH38:
    s_mov_b32 s90, 300000
LSPH37:
    ds_read_b32 v46, v7 offset:208
    s_sub_u32 s90, s90, 1
    s_waitcnt lgkmcnt(0)
    s_cbranch_scc1 LOKH36
    v_cmp_ne_u32 vcc, 1, v46
    s_nop 1
    s_cbranch_vccnz LSPH37
    s_branch LOKH36
LSLH41:
    s_mov_b32 s90, 300000
LSPH40:
    ds_read_b32 v46, v7 offset:144
    s_sub_u32 s90, s90, 1
    s_waitcnt lgkmcnt(0)
    s_cbranch_scc1 LOKH39
    v_cmp_ne_u32 vcc, 1, v46
    s_nop 1
    s_cbranch_vccnz LSPH40
    s_branch LOKH39
LSLC4:
    s_mov_b32 s90, 300000
LSPC3:
    ds_read_b32 v9, v7 offset:0
    s_sub_u32 s90, s90, 1
    s_waitcnt lgkmcnt(0)
    s_cbranch_scc1 LOKC2
    v_cmp_ne_u32 vcc, 1, v9
    s_nop 1
    s_cbranch_vccnz LSPC3
    s_branch LOKC2
LSLC7:
    s_mov_b32 s90, 300000
LSPC6:
    ds_read_b32 v9, v7 offset:48
    s_sub_u32 s90, s90, 1
    s_waitcnt lgkmcnt(0)
    s_cbranch_scc1 LOKC5
    v_cmp_ne_u32 vcc, 1, v9
    s_nop 1
    s_cbranch_vccnz LSPC6
    s_branch LOKC5
LSLC10:
    s_mov_b32 s90, 300000
LSPC9:
    ds_read_b32 v9, v7 offset:64
    s_sub_u32 s90, s90, 1
    s_waitcnt lgkmcnt(0)
    s_cbranch_scc1 LOKC8
    v_cmp_ne_u32 vcc, 1, v9
    s_nop 1
    s_cbranch_vccnz LSPC9
    s_branch LOKC8
LSLOWC13:
    s_mov_b32 s90, 30000
LPOLLC12:
    s_sleep 4
    buffer_load_dword v4, v5, s[56:59], s17 offen sc1
    s_sub_u32 s90, s90, 1
    s_waitcnt vmcnt(0)
    s_cbranch_scc1 LOKC11
    v_cmp_ne_u32 vcc, s74, v4
    s_nop 1
    s_cbranch_vccnz LPOLLC12
    s_branch LOKC11
LSLC16:
    s_mov_b32 s90, 300000
LSPC15:
    ds_read_b32 v9, v7 offset:112
    s_sub_u32 s90, s90, 1
    s_waitcnt lgkmcnt(0)
    s_cbranch_scc1 LOKC14
    v_cmp_ne_u32 vcc, 1, v9
    s_nop 1
    s_cbranch_vccnz LSPC15
    s_branch LOKC14
LSLC19:
    s_mov_b32 s90, 300000
LSPC18:
    ds_read_b32 v9, v7 offset:240
    s_sub_u32 s90, s90, 1
    s_waitcnt lgkmcnt(0)
    s_cbranch_scc1 LOKC17
    v_cmp_ne_u32 vcc, 1, v9
    s_nop 1
    s_cbranch_vccnz LSPC18
    s_branch LOKC17
LSLC22:
    s_mov_b32 s90, 300000
LSPC21:
    ds_read_b32 v9, v7 offset:128
    s_sub_u32 s90, s90, 1
    s_waitcnt lgkmcnt(0)
    s_cbranch_scc1 LOKC20
    v_cmp_ne_u32 vcc, 1, v9
    s_nop 1
    s_cbranch_vccnz LSPC21
    s_branch LOKC20
LSLC25:
    s_mov_b32 s90, 300000
LSPC24:
    ds_read_b32 v18, v7 offset:208
    s_sub_u32 s90, s90, 1
    s_waitcnt lgkmcnt(0)
    s_cbranch_scc1 LOKC23
    v_cmp_ne_u32 vcc, 1, v18
    s_nop 1
    s_cbranch_vccnz LSPC24
    s_branch LOKC23
LEND:
LLAST:
    s_endpgm
.section .rodata,"a"
.p2align 6
.amdhsa_kernel parallel_sum__ssm_conv_h3__dense_activation_silu__prompt_kernel
  .amdhsa_next_free_vgpr 256
  .amdhsa_next_free_sgpr 102
  .amdhsa_accum_offset 256
  .amdhsa_group_segment_fixed_size 0
  .amdhsa_kernarg_size 96
  .amdhsa_user_sgpr_count 2
  .amdhsa_user_sgpr_kernarg_segment_ptr 1
  .amdhsa_system_sgpr_workgroup_id_x 1
.end_amdhsa_kernel
```
